```python
import torch

def _softmax(x, axis=-1):
    return torch.softmax(x, dim=axis)

def _gelu(x):
    return torch.nn.functional.gelu(x, approximate='tanh')

def _silu(x):
    return torch.nn.functional.silu(x)

def _sigmoid(x):
    return torch.sigmoid(x)

def _layernorm(x, axis=-1, eps=1e-05):
    m = x.mean(dim=axis, keepdim=True)
    v = x.var(dim=axis, keepdim=True, unbiased=False)
    return (x - m) / torch.sqrt(v + eps)

def _scatter_add(tgt, idx, src, axis=0):
    return tgt.clone().index_add_(axis, idx, src)

def _segment_sum(src, seg, n):
    out = torch.zeros((n,) + src.shape[1:], dtype=src.dtype)
    return out.index_add_(0, seg, src)

def _pad(x, pw):
    flat = tuple((v for pair in reversed(pw) for v in pair))
    return torch.nn.functional.pad(x, flat)
kernel_name = 'recurrent_scan__memory_aug_recurrent_mem_tr__mixer_channel_mlp__prompt'

def setup_inputs():

    _w = lambda a: (lambda t: t.to(torch.bfloat16) if t.is_floating_point() else t)(torch.as_tensor(a))

    def _A_setup():
        B, S, Dm = (1, 2048, 512)
        H, Dh = (32, 128)
        M, seg = (8, 32)
        seg = min(seg, S)
        S = S // seg * seg
        return {'x': _w((lambda *s: torch.randn(*s, dtype=torch.bfloat16) * 0.05)(B, S, Dm)), 'mem0': _w((lambda *s: torch.randn(*s, dtype=torch.bfloat16) * 0.8)(B, M, Dm)), 'Wq': _w((lambda *s: torch.randn(*s, dtype=torch.bfloat16) * 0.8)(Dm, H, Dh) * Dm ** (-0.5)), 'Wk': _w((lambda *s: torch.randn(*s, dtype=torch.bfloat16) * 0.8)(Dm, H, Dh) * Dm ** (-0.5)), 'Wv': _w((lambda *s: torch.randn(*s, dtype=torch.bfloat16) * 0.8)(Dm, H, Dh) * Dm ** (-0.5)), 'Wo': _w((lambda *s: torch.randn(*s, dtype=torch.bfloat16) * 0.8)(H, Dh, Dm) * (H * Dh) ** (-0.5)), 'seg_len': seg}
    _A_in = _A_setup()

    def _B_setup():
        B, S, D, F = (1, 2048, 512, 1376)
        return {'x': _w((lambda *s: torch.randn(*s, dtype=torch.bfloat16) * 0.05)(B, S, D)), 'w1': _w((lambda *s: torch.randn(*s, dtype=torch.bfloat16) * 0.8)(D, F) * D ** (-0.5)), 'b1': _w((lambda *s: torch.randn(*s, dtype=torch.bfloat16) * 0.4)(F)), 'w2': _w((lambda *s: torch.randn(*s, dtype=torch.bfloat16) * 0.2)(F, D) * F ** (-0.5)), 'b2': _w((lambda *s: torch.randn(*s, dtype=torch.bfloat16) * 0.2)(D))}
    _B_in = _B_setup()
    return {'A_x': _A_in['x'], 'A_mem0': _A_in['mem0'], 'A_Wq': _A_in['Wq'], 'A_Wk': _A_in['Wk'], 'A_Wv': _A_in['Wv'], 'A_Wo': _A_in['Wo'], 'A_seg_len': _A_in['seg_len'], 'B_x': _B_in['x'], 'B_w1': _B_in['w1'], 'B_b1': _B_in['b1'], 'B_w2': _B_in['w2'], 'B_b2': _B_in['b2']}

def reference(A_x, A_mem0, A_Wq, A_Wk, A_Wv, A_Wo, A_seg_len, B_x, B_w1, B_b1, B_w2, B_b2):

    def _A_ref(x, mem0, Wq, Wk, Wv, Wo, seg_len):
        B, S, Dm = x.shape
        H, Dh = (Wq.shape[1], Wq.shape[2])
        M = mem0.shape[1]
        scale = Dh ** (-0.5)
        n_seg = S // seg_len
        L = M + seg_len
        idx = torch.arange(L)
        mask = (idx[:, None] < M) | (idx[:, None] >= idx[None, :])
        mem = mem0
        outs = []
        for s in range(n_seg):
            xs = x[:, s * seg_len:(s + 1) * seg_len, :].clone()
            h = torch.concatenate([mem, xs], axis=1)
            q = torch.einsum('btd,dhe->bhte', h, Wq)
            k = torch.einsum('btd,dhe->bhte', h, Wk)
            v = torch.einsum('btd,dhe->bhte', h, Wv)
            scores = torch.einsum('bhqe,bhke->bhqk', q, k) * scale
            scores = torch.where(mask[None, None], scores, -1000000000.0)
            p = _softmax(scores, axis=-1)
            o = torch.einsum('bhqk,bhke->bhqe', p, v)
            o = torch.einsum('bhte,hed->btd', o, Wo)
            mem = o[:, :M, :].clone()
            outs.append(o[:, M:, :])
        return torch.concatenate(outs, axis=1)

    def _B_ref(x, w1, b1, w2, b2):
        y = _layernorm(x, axis=-1)
        h = _gelu(torch.einsum('bsd,df->bsf', y, w1) + b1)
        return torch.einsum('bsf,fd->bsd', h, w2) + b2
    x = A_x
    xn = _layernorm(x, axis=-1)
    s = _A_ref(xn, A_mem0, A_Wq, A_Wk, A_Wv, A_Wo, A_seg_len)
    g = _silu(_B_ref(xn, B_w1, B_b1, B_w2, B_b2))
    return x + s * g
```

```asm
; @launch kernel=k0_kernel grid=(6320,1,1) block=(256,1,1) lds=0
; @launch kernel=k2_kernel grid=(256,1,1) block=(256,1,1) lds=0
; @launch kernel=k3_kernel grid=(256,1,1) block=(256,1,1) lds=153600
; @launch kernel=k4_kernel grid=(512,1,1) block=(256,1,1) lds=0
; @launch kernel=k5_kernel grid=(256,1,1) block=(256,1,1) lds=0
.amdgcn_target "amdgcn-amd-amdhsa--gfx950"
.text
    .globl k0_kernel
    .p2align 8
    .type k0_kernel,@function
k0_kernel:
    s_load_dwordx16 s[8:23], s[0:1], 0
    s_load_dwordx8 s[24:31], s[0:1], 64
    s_load_dwordx2 s[32:33], s[0:1], 112
    v_lshrrev_b32 v1, 6, v0
    v_and_b32 v2, 63, v0
    v_readfirstlane_b32 s3, v1
    s_waitcnt lgkmcnt(0)
    s_cmp_ge_u32 s2, 6320
    s_cbranch_scc1 k0_end
    s_cmp_ge_u32 s2, 5808
    s_cbranch_scc1 k0_ln
    s_lshl_b32 s4, s2, 2
    s_add_u32 s4, s4, s3
    s_mov_b32 s40, 0
    s_cmp_ge_u32 s4, 12288
    s_cbranch_scc1 k0_d1
    s_lshr_b32 s5, s4, 12
    s_and_b32 s6, s4, 4095
    s_lshr_b32 s38, s6, 4
    s_lshl_b32 s38, s38, 4
    s_and_b32 s37, s6, 15
    s_lshl_b32 s37, s37, 5
    s_mov_b32 s36, 8192
    s_mov_b32 s41, 4194304
    s_mov_b32 s34, s12
    s_mov_b32 s35, s13
    s_cmp_eq_u32 s5, 1
    s_cselect_b32 s34, s14, s34
    s_cselect_b32 s35, s15, s35
    s_cmp_eq_u32 s5, 2
    s_cselect_b32 s34, s16, s34
    s_cselect_b32 s35, s17, s35
    s_lshl_b32 s39, s4, 10
    s_add_u32 s39, s39, 4194304
    s_branch k0_go
k0_d1:
    s_cmp_ge_u32 s4, 16384
    s_cbranch_scc1 k0_d2
    s_sub_u32 s5, s4, 12288
    s_lshr_b32 s6, s5, 7
    s_lshl_b32 s37, s6, 7
    s_and_b32 s6, s5, 3
    s_lshl_b32 s6, s6, 5
    s_add_u32 s37, s37, s6
    s_bfe_u32 s38, s5, 0x50002
    s_lshl_b32 s38, s38, 4
    s_mov_b32 s36, 1024
    s_mov_b32 s41, 4194304
    s_mov_b32 s34, s18
    s_mov_b32 s35, s19
    s_mov_b32 s40, 1
    s_lshl_b32 s39, s5, 10
    s_add_u32 s39, s39, 16777216
    s_branch k0_go
k0_d2:
    s_cmp_ge_u32 s4, 20480
    s_cbranch_scc1 k0_d3
    s_sub_u32 s5, s4, 16384
    s_lshr_b32 s38, s5, 7
    s_lshl_b32 s38, s38, 4
    s_and_b32 s37, s5, 127
    s_lshl_b32 s37, s37, 5
    s_mov_b32 s36, 1024
    s_mov_b32 s41, 4194304
    s_mov_b32 s34, s18
    s_mov_b32 s35, s19
    s_lshl_b32 s39, s5, 10
    s_add_u32 s39, s39, 20971520
    s_branch k0_go
k0_d3:
    s_cmp_ge_u32 s4, 21856
    s_cbranch_scc1 k0_d4
    s_sub_u32 s5, s4, 20480
    s_lshr_b32 s38, s5, 4
    s_lshl_b32 s38, s38, 4
    s_and_b32 s37, s5, 15
    s_lshl_b32 s37, s37, 5
    s_mov_b32 s36, 2752
    s_mov_b32 s41, 1409024
    s_mov_b32 s34, s24
    s_mov_b32 s35, s25
    s_lshl_b32 s39, s5, 10
    s_add_u32 s39, s39, 25165824
    s_branch k0_go
k0_d4:
    s_sub_u32 s5, s4, 21856
    s_mul_i32 s6, s5, 1525
    s_lshr_b32 s6, s6, 16
    s_lshl_b32 s38, s6, 4
    s_mul_i32 s6, s6, 43
    s_sub_u32 s37, s5, s6
    s_lshl_b32 s37, s37, 5
    s_mov_b32 s36, 1024
    s_mov_b32 s41, 1409024
    s_mov_b32 s34, s28
    s_mov_b32 s35, s29
    s_lshl_b32 s39, s5, 10
    s_add_u32 s39, s39, 27262976
k0_go:
    s_mov_b32 s44, s34
    s_and_b32 s45, s35, 0xffff
    s_mov_b32 s46, s41
    s_mov_b32 s47, 0x00020000
    s_mov_b32 s48, s32
    s_and_b32 s49, s33, 0xffff
    s_mov_b32 s50, 268435456
    s_mov_b32 s51, 0x00020000
    v_lshrrev_b32 v3, 4, v2
    v_and_b32 v4, 15, v2
    s_sub_u32 s5, 3, s40
    v_lshlrev_b32 v3, s5, v3
    v_add_u32 v3, s37, v3
    v_mul_lo_u32 v3, v3, s36
    v_add_u32 v4, s38, v4
    v_lshlrev_b32 v4, 1, v4
    v_add_u32 v3, v3, v4
    s_mul_i32 s6, s40, 12
    s_mul_i32 s7, s36, 0
    buffer_load_ushort v8, v3, s[44:47], s7 offen
    s_mul_i32 s7, s36, 1
    buffer_load_ushort v9, v3, s[44:47], s7 offen
    s_mul_i32 s7, s36, 2
    buffer_load_ushort v10, v3, s[44:47], s7 offen
    s_mul_i32 s7, s36, 3
    buffer_load_ushort v11, v3, s[44:47], s7 offen
    s_add_u32 s7, s6, 4
    s_mul_i32 s7, s7, s36
    buffer_load_ushort v12, v3, s[44:47], s7 offen
    s_add_u32 s7, s6, 5
    s_mul_i32 s7, s7, s36
    buffer_load_ushort v13, v3, s[44:47], s7 offen
    s_add_u32 s7, s6, 6
    s_mul_i32 s7, s7, s36
    buffer_load_ushort v14, v3, s[44:47], s7 offen
    s_add_u32 s7, s6, 7
    s_mul_i32 s7, s7, s36
    buffer_load_ushort v15, v3, s[44:47], s7 offen
    s_waitcnt vmcnt(0)
    v_lshl_or_b32 v16, v9, 16, v8
    v_lshl_or_b32 v17, v11, 16, v10
    v_lshl_or_b32 v18, v13, 16, v12
    v_lshl_or_b32 v19, v15, 16, v14
    v_lshlrev_b32 v5, 4, v2
    v_add_u32 v5, s39, v5
    buffer_store_dwordx4 v[16:19], v5, s[48:51], 0 offen
    s_endpgm
k0_ln:
    s_sub_u32 s4, s2, 5808
    s_lshl_b32 s5, s4, 2
    s_add_u32 s5, s5, s3
    s_lshl_b32 s5, s5, 10
    s_mov_b32 s44, s8
    s_and_b32 s45, s9, 0xffff
    s_mov_b32 s46, 2097152
    s_mov_b32 s47, 0x00020000
    s_mov_b32 s48, s32
    s_and_b32 s49, s33, 0xffff
    s_mov_b32 s50, 268435456
    s_mov_b32 s51, 0x00020000
    v_lshlrev_b32 v3, 4, v2
    v_add_u32 v3, s5, v3
    buffer_load_dwordx4 v[4:7], v3, s[44:47], 0 offen
    s_waitcnt vmcnt(0)
    v_lshlrev_b32 v8, 16, v4
    v_and_b32 v9, 0xffff0000, v4
    v_lshlrev_b32 v10, 16, v5
    v_and_b32 v11, 0xffff0000, v5
    v_lshlrev_b32 v12, 16, v6
    v_and_b32 v13, 0xffff0000, v6
    v_lshlrev_b32 v14, 16, v7
    v_and_b32 v15, 0xffff0000, v7
    v_add_f32 v16, v8, v9
    v_add_f32 v16, v16, v10
    v_add_f32 v16, v16, v11
    v_add_f32 v16, v16, v12
    v_add_f32 v16, v16, v13
    v_add_f32 v16, v16, v14
    v_add_f32 v16, v16, v15
    ds_swizzle_b32 v17, v16 offset:1055
    s_waitcnt lgkmcnt(0)
    v_add_f32 v16, v16, v17
    ds_swizzle_b32 v17, v16 offset:2079
    s_waitcnt lgkmcnt(0)
    v_add_f32 v16, v16, v17
    ds_swizzle_b32 v17, v16 offset:4127
    s_waitcnt lgkmcnt(0)
    v_add_f32 v16, v16, v17
    ds_swizzle_b32 v17, v16 offset:8223
    s_waitcnt lgkmcnt(0)
    v_add_f32 v16, v16, v17
    ds_swizzle_b32 v17, v16 offset:16415
    s_waitcnt lgkmcnt(0)
    v_add_f32 v16, v16, v17
    s_nop 1
    v_readlane_b32 s6, v16, 0
    v_readlane_b32 s7, v16, 32
    s_nop 1
    v_mov_b32 v16, s6
    s_nop 1
    v_add_f32 v16, s7, v16
    v_mul_f32 v16, 0x3b000000, v16
    v_sub_f32 v8, v8, v16
    v_sub_f32 v9, v9, v16
    v_sub_f32 v10, v10, v16
    v_sub_f32 v11, v11, v16
    v_sub_f32 v12, v12, v16
    v_sub_f32 v13, v13, v16
    v_sub_f32 v14, v14, v16
    v_sub_f32 v15, v15, v16
    v_mul_f32 v16, v8, v8
    v_fmac_f32 v16, v9, v9
    v_fmac_f32 v16, v10, v10
    v_fmac_f32 v16, v11, v11
    v_fmac_f32 v16, v12, v12
    v_fmac_f32 v16, v13, v13
    v_fmac_f32 v16, v14, v14
    v_fmac_f32 v16, v15, v15
    ds_swizzle_b32 v17, v16 offset:1055
    s_waitcnt lgkmcnt(0)
    v_add_f32 v16, v16, v17
    ds_swizzle_b32 v17, v16 offset:2079
    s_waitcnt lgkmcnt(0)
    v_add_f32 v16, v16, v17
    ds_swizzle_b32 v17, v16 offset:4127
    s_waitcnt lgkmcnt(0)
    v_add_f32 v16, v16, v17
    ds_swizzle_b32 v17, v16 offset:8223
    s_waitcnt lgkmcnt(0)
    v_add_f32 v16, v16, v17
    ds_swizzle_b32 v17, v16 offset:16415
    s_waitcnt lgkmcnt(0)
    v_add_f32 v16, v16, v17
    s_nop 1
    v_readlane_b32 s6, v16, 0
    v_readlane_b32 s7, v16, 32
    s_nop 1
    v_mov_b32 v16, s6
    s_nop 1
    v_add_f32 v16, s7, v16
    v_mul_f32 v16, 0x3b000000, v16
    v_add_f32 v16, 0x3727c5ac, v16
    v_sqrt_f32 v16, v16
    s_nop 0
    v_rcp_f32 v16, v16
    s_nop 0
    v_mul_f32 v8, v8, v16
    v_mul_f32 v9, v9, v16
    v_mul_f32 v10, v10, v16
    v_mul_f32 v11, v11, v16
    v_mul_f32 v12, v12, v16
    v_mul_f32 v13, v13, v16
    v_mul_f32 v14, v14, v16
    v_mul_f32 v15, v15, v16
    v_cvt_pk_bf16_f32 v4, v8, v9
    v_cvt_pk_bf16_f32 v5, v10, v11
    v_cvt_pk_bf16_f32 v6, v12, v13
    v_cvt_pk_bf16_f32 v7, v14, v15
    v_add_u32 v3, 0, v3
    buffer_store_dwordx4 v[4:7], v3, s[48:51], 0 offen
    v_mov_b32 v8, 0
    v_mov_b32 v9, 0
    v_mov_b32 v10, 0
    v_mov_b32 v11, 0
    s_lshl_b32 s6, s4, 12
    v_lshlrev_b32 v12, 4, v0
    v_add_u32 v12, s6, v12
    v_add_u32 v13, 117440512, v12
    buffer_store_dwordx4 v[8:11], v13, s[48:51], 0 offen
    s_cmp_ge_u32 s4, 20
    s_cbranch_scc1 k0_end
    v_add_u32 v13, 119537664, v12
    buffer_store_dwordx4 v[8:11], v13, s[48:51], 0 offen
k0_end:
    s_endpgm
    .globl k2_kernel
    .p2align 8
    .type k2_kernel,@function
k2_kernel:
    s_cmp_ge_u32 s2, 256
    s_cbranch_scc1 k2_end
    s_load_dwordx2 s[32:33], s[0:1], 112
    v_lshrrev_b32 v1, 6, v0
    v_and_b32 v2, 63, v0
    v_readfirstlane_b32 s3, v1
    s_and_b32 s4, s2, 7
    s_lshr_b32 s5, s2, 3
    s_lshl_b32 s6, s4, 8
    s_lshl_b32 s7, s3, 6
    s_add_u32 s6, s6, s7
    s_mul_i32 s8, s5, 24
    s_waitcnt lgkmcnt(0)
    s_mov_b32 s48, s32
    s_and_b32 s49, s33, 0xffff
    s_mov_b32 s50, 268435456
    s_mov_b32 s51, 0x00020000
    v_lshrrev_b32 v3, 4, v2
    v_and_b32 v4, 15, v2
    v_add_u32 v5, s6, v4
    v_lshlrev_b32 v5, 10, v5
    v_lshl_add_u32 v5, v3, 4, v5
    v_lshlrev_b32 v6, 4, v2
    v_add_u32 v7, 0, v5
    buffer_load_dwordx4 a[0:3], v7, s[48:51], 0 offen offset:0
    buffer_load_dwordx4 a[4:7], v7, s[48:51], 0 offen offset:64
    buffer_load_dwordx4 a[8:11], v7, s[48:51], 0 offen offset:128
    buffer_load_dwordx4 a[12:15], v7, s[48:51], 0 offen offset:192
    buffer_load_dwordx4 a[16:19], v7, s[48:51], 0 offen offset:256
    buffer_load_dwordx4 a[20:23], v7, s[48:51], 0 offen offset:320
    buffer_load_dwordx4 a[24:27], v7, s[48:51], 0 offen offset:384
    buffer_load_dwordx4 a[28:31], v7, s[48:51], 0 offen offset:448
    buffer_load_dwordx4 a[32:35], v7, s[48:51], 0 offen offset:512
    buffer_load_dwordx4 a[36:39], v7, s[48:51], 0 offen offset:576
    buffer_load_dwordx4 a[40:43], v7, s[48:51], 0 offen offset:640
    buffer_load_dwordx4 a[44:47], v7, s[48:51], 0 offen offset:704
    buffer_load_dwordx4 a[48:51], v7, s[48:51], 0 offen offset:768
    buffer_load_dwordx4 a[52:55], v7, s[48:51], 0 offen offset:832
    buffer_load_dwordx4 a[56:59], v7, s[48:51], 0 offen offset:896
    buffer_load_dwordx4 a[60:63], v7, s[48:51], 0 offen offset:960
    v_add_u32 v7, 16384, v5
    buffer_load_dwordx4 a[64:67], v7, s[48:51], 0 offen offset:0
    buffer_load_dwordx4 a[68:71], v7, s[48:51], 0 offen offset:64
    buffer_load_dwordx4 a[72:75], v7, s[48:51], 0 offen offset:128
    buffer_load_dwordx4 a[76:79], v7, s[48:51], 0 offen offset:192
    buffer_load_dwordx4 a[80:83], v7, s[48:51], 0 offen offset:256
    buffer_load_dwordx4 a[84:87], v7, s[48:51], 0 offen offset:320
    buffer_load_dwordx4 a[88:91], v7, s[48:51], 0 offen offset:384
    buffer_load_dwordx4 a[92:95], v7, s[48:51], 0 offen offset:448
    buffer_load_dwordx4 a[96:99], v7, s[48:51], 0 offen offset:512
    buffer_load_dwordx4 a[100:103], v7, s[48:51], 0 offen offset:576
    buffer_load_dwordx4 a[104:107], v7, s[48:51], 0 offen offset:640
    buffer_load_dwordx4 a[108:111], v7, s[48:51], 0 offen offset:704
    buffer_load_dwordx4 a[112:115], v7, s[48:51], 0 offen offset:768
    buffer_load_dwordx4 a[116:119], v7, s[48:51], 0 offen offset:832
    buffer_load_dwordx4 a[120:123], v7, s[48:51], 0 offen offset:896
    buffer_load_dwordx4 a[124:127], v7, s[48:51], 0 offen offset:960
    v_add_u32 v7, 32768, v5
    buffer_load_dwordx4 a[128:131], v7, s[48:51], 0 offen offset:0
    buffer_load_dwordx4 a[132:135], v7, s[48:51], 0 offen offset:64
    buffer_load_dwordx4 a[136:139], v7, s[48:51], 0 offen offset:128
    buffer_load_dwordx4 a[140:143], v7, s[48:51], 0 offen offset:192
    buffer_load_dwordx4 a[144:147], v7, s[48:51], 0 offen offset:256
    buffer_load_dwordx4 a[148:151], v7, s[48:51], 0 offen offset:320
    buffer_load_dwordx4 a[152:155], v7, s[48:51], 0 offen offset:384
    buffer_load_dwordx4 a[156:159], v7, s[48:51], 0 offen offset:448
    buffer_load_dwordx4 a[160:163], v7, s[48:51], 0 offen offset:512
    buffer_load_dwordx4 a[164:167], v7, s[48:51], 0 offen offset:576
    buffer_load_dwordx4 a[168:171], v7, s[48:51], 0 offen offset:640
    buffer_load_dwordx4 a[172:175], v7, s[48:51], 0 offen offset:704
    buffer_load_dwordx4 a[176:179], v7, s[48:51], 0 offen offset:768
    buffer_load_dwordx4 a[180:183], v7, s[48:51], 0 offen offset:832
    buffer_load_dwordx4 a[184:187], v7, s[48:51], 0 offen offset:896
    buffer_load_dwordx4 a[188:191], v7, s[48:51], 0 offen offset:960
    v_add_u32 v7, 49152, v5
    buffer_load_dwordx4 a[192:195], v7, s[48:51], 0 offen offset:0
    buffer_load_dwordx4 a[196:199], v7, s[48:51], 0 offen offset:64
    buffer_load_dwordx4 a[200:203], v7, s[48:51], 0 offen offset:128
    buffer_load_dwordx4 a[204:207], v7, s[48:51], 0 offen offset:192
    buffer_load_dwordx4 a[208:211], v7, s[48:51], 0 offen offset:256
    buffer_load_dwordx4 a[212:215], v7, s[48:51], 0 offen offset:320
    buffer_load_dwordx4 a[216:219], v7, s[48:51], 0 offen offset:384
    buffer_load_dwordx4 a[220:223], v7, s[48:51], 0 offen offset:448
    buffer_load_dwordx4 a[224:227], v7, s[48:51], 0 offen offset:512
    buffer_load_dwordx4 a[228:231], v7, s[48:51], 0 offen offset:576
    buffer_load_dwordx4 a[232:235], v7, s[48:51], 0 offen offset:640
    buffer_load_dwordx4 a[236:239], v7, s[48:51], 0 offen offset:704
    buffer_load_dwordx4 a[240:243], v7, s[48:51], 0 offen offset:768
    buffer_load_dwordx4 a[244:247], v7, s[48:51], 0 offen offset:832
    buffer_load_dwordx4 a[248:251], v7, s[48:51], 0 offen offset:896
    buffer_load_dwordx4 a[252:255], v7, s[48:51], 0 offen offset:960
    s_mov_b32 s9, 0
    s_lshl_b32 s11, s8, 14
    s_add_u32 s11, s11, 4194304
    s_add_u32 s10, s11, 0
    buffer_load_dwordx4 v[64:67], v6, s[48:51], s10 offen offset:0
    buffer_load_dwordx4 v[68:71], v6, s[48:51], s10 offen offset:1024
    buffer_load_dwordx4 v[72:75], v6, s[48:51], s10 offen offset:2048
    buffer_load_dwordx4 v[76:79], v6, s[48:51], s10 offen offset:3072
    s_add_u32 s10, s11, 4096
    buffer_load_dwordx4 v[80:83], v6, s[48:51], s10 offen offset:0
    buffer_load_dwordx4 v[84:87], v6, s[48:51], s10 offen offset:1024
    buffer_load_dwordx4 v[88:91], v6, s[48:51], s10 offen offset:2048
    buffer_load_dwordx4 v[92:95], v6, s[48:51], s10 offen offset:3072
    s_add_u32 s10, s11, 8192
    buffer_load_dwordx4 v[96:99], v6, s[48:51], s10 offen offset:0
    buffer_load_dwordx4 v[100:103], v6, s[48:51], s10 offen offset:1024
    buffer_load_dwordx4 v[104:107], v6, s[48:51], s10 offen offset:2048
    buffer_load_dwordx4 v[108:111], v6, s[48:51], s10 offen offset:3072
    s_add_u32 s10, s11, 12288
    buffer_load_dwordx4 v[112:115], v6, s[48:51], s10 offen offset:0
    buffer_load_dwordx4 v[116:119], v6, s[48:51], s10 offen offset:1024
    buffer_load_dwordx4 v[120:123], v6, s[48:51], s10 offen offset:2048
    buffer_load_dwordx4 v[124:127], v6, s[48:51], s10 offen offset:3072
k2_loop_1:
    s_add_u32 s11, s11, 16384
    s_add_u32 s10, s11, 0
    buffer_load_dwordx4 v[128:131], v6, s[48:51], s10 offen offset:0
    buffer_load_dwordx4 v[132:135], v6, s[48:51], s10 offen offset:1024
    buffer_load_dwordx4 v[136:139], v6, s[48:51], s10 offen offset:2048
    buffer_load_dwordx4 v[140:143], v6, s[48:51], s10 offen offset:3072
    s_add_u32 s10, s11, 4096
    buffer_load_dwordx4 v[144:147], v6, s[48:51], s10 offen offset:0
    buffer_load_dwordx4 v[148:151], v6, s[48:51], s10 offen offset:1024
    buffer_load_dwordx4 v[152:155], v6, s[48:51], s10 offen offset:2048
    buffer_load_dwordx4 v[156:159], v6, s[48:51], s10 offen offset:3072
    s_add_u32 s10, s11, 8192
    buffer_load_dwordx4 v[160:163], v6, s[48:51], s10 offen offset:0
    buffer_load_dwordx4 v[164:167], v6, s[48:51], s10 offen offset:1024
    buffer_load_dwordx4 v[168:171], v6, s[48:51], s10 offen offset:2048
    buffer_load_dwordx4 v[172:175], v6, s[48:51], s10 offen offset:3072
    s_add_u32 s10, s11, 12288
    buffer_load_dwordx4 v[176:179], v6, s[48:51], s10 offen offset:0
    buffer_load_dwordx4 v[180:183], v6, s[48:51], s10 offen offset:1024
    buffer_load_dwordx4 v[184:187], v6, s[48:51], s10 offen offset:2048
    buffer_load_dwordx4 v[188:191], v6, s[48:51], s10 offen offset:3072
    s_waitcnt vmcnt(16)
    s_add_u32 s12, s8, s9
    s_cmp_ge_u32 s12, 512
    s_cbranch_scc1 k2_v_2
    v_mfma_f32_16x16x32_bf16 v[16:19], v[64:67], a[0:3], 0
    v_mfma_f32_16x16x32_bf16 v[20:23], v[64:67], a[64:67], 0
    v_mfma_f32_16x16x32_bf16 v[24:27], v[64:67], a[128:131], 0
    v_mfma_f32_16x16x32_bf16 v[28:31], v[64:67], a[192:195], 0
    v_mfma_f32_16x16x32_bf16 v[16:19], v[68:71], a[4:7], v[16:19]
    v_mfma_f32_16x16x32_bf16 v[20:23], v[68:71], a[68:71], v[20:23]
    v_mfma_f32_16x16x32_bf16 v[24:27], v[68:71], a[132:135], v[24:27]
    v_mfma_f32_16x16x32_bf16 v[28:31], v[68:71], a[196:199], v[28:31]
    v_mfma_f32_16x16x32_bf16 v[16:19], v[72:75], a[8:11], v[16:19]
    v_mfma_f32_16x16x32_bf16 v[20:23], v[72:75], a[72:75], v[20:23]
    v_mfma_f32_16x16x32_bf16 v[24:27], v[72:75], a[136:139], v[24:27]
    v_mfma_f32_16x16x32_bf16 v[28:31], v[72:75], a[200:203], v[28:31]
    v_mfma_f32_16x16x32_bf16 v[16:19], v[76:79], a[12:15], v[16:19]
    v_mfma_f32_16x16x32_bf16 v[20:23], v[76:79], a[76:79], v[20:23]
    v_mfma_f32_16x16x32_bf16 v[24:27], v[76:79], a[140:143], v[24:27]
    v_mfma_f32_16x16x32_bf16 v[28:31], v[76:79], a[204:207], v[28:31]
    v_mfma_f32_16x16x32_bf16 v[16:19], v[80:83], a[16:19], v[16:19]
    v_mfma_f32_16x16x32_bf16 v[20:23], v[80:83], a[80:83], v[20:23]
    v_mfma_f32_16x16x32_bf16 v[24:27], v[80:83], a[144:147], v[24:27]
    v_mfma_f32_16x16x32_bf16 v[28:31], v[80:83], a[208:211], v[28:31]
    v_mfma_f32_16x16x32_bf16 v[16:19], v[84:87], a[20:23], v[16:19]
    v_mfma_f32_16x16x32_bf16 v[20:23], v[84:87], a[84:87], v[20:23]
    v_mfma_f32_16x16x32_bf16 v[24:27], v[84:87], a[148:151], v[24:27]
    v_mfma_f32_16x16x32_bf16 v[28:31], v[84:87], a[212:215], v[28:31]
    v_mfma_f32_16x16x32_bf16 v[16:19], v[88:91], a[24:27], v[16:19]
    v_mfma_f32_16x16x32_bf16 v[20:23], v[88:91], a[88:91], v[20:23]
    v_mfma_f32_16x16x32_bf16 v[24:27], v[88:91], a[152:155], v[24:27]
    v_mfma_f32_16x16x32_bf16 v[28:31], v[88:91], a[216:219], v[28:31]
    v_mfma_f32_16x16x32_bf16 v[16:19], v[92:95], a[28:31], v[16:19]
    v_mfma_f32_16x16x32_bf16 v[20:23], v[92:95], a[92:95], v[20:23]
    v_mfma_f32_16x16x32_bf16 v[24:27], v[92:95], a[156:159], v[24:27]
    v_mfma_f32_16x16x32_bf16 v[28:31], v[92:95], a[220:223], v[28:31]
    v_mfma_f32_16x16x32_bf16 v[16:19], v[96:99], a[32:35], v[16:19]
    v_mfma_f32_16x16x32_bf16 v[20:23], v[96:99], a[96:99], v[20:23]
    v_mfma_f32_16x16x32_bf16 v[24:27], v[96:99], a[160:163], v[24:27]
    v_mfma_f32_16x16x32_bf16 v[28:31], v[96:99], a[224:227], v[28:31]
    v_mfma_f32_16x16x32_bf16 v[16:19], v[100:103], a[36:39], v[16:19]
    v_mfma_f32_16x16x32_bf16 v[20:23], v[100:103], a[100:103], v[20:23]
    v_mfma_f32_16x16x32_bf16 v[24:27], v[100:103], a[164:167], v[24:27]
    v_mfma_f32_16x16x32_bf16 v[28:31], v[100:103], a[228:231], v[28:31]
    v_mfma_f32_16x16x32_bf16 v[16:19], v[104:107], a[40:43], v[16:19]
    v_mfma_f32_16x16x32_bf16 v[20:23], v[104:107], a[104:107], v[20:23]
    v_mfma_f32_16x16x32_bf16 v[24:27], v[104:107], a[168:171], v[24:27]
    v_mfma_f32_16x16x32_bf16 v[28:31], v[104:107], a[232:235], v[28:31]
    v_mfma_f32_16x16x32_bf16 v[16:19], v[108:111], a[44:47], v[16:19]
    v_mfma_f32_16x16x32_bf16 v[20:23], v[108:111], a[108:111], v[20:23]
    v_mfma_f32_16x16x32_bf16 v[24:27], v[108:111], a[172:175], v[24:27]
    v_mfma_f32_16x16x32_bf16 v[28:31], v[108:111], a[236:239], v[28:31]
    v_mfma_f32_16x16x32_bf16 v[16:19], v[112:115], a[48:51], v[16:19]
    v_mfma_f32_16x16x32_bf16 v[20:23], v[112:115], a[112:115], v[20:23]
    v_mfma_f32_16x16x32_bf16 v[24:27], v[112:115], a[176:179], v[24:27]
    v_mfma_f32_16x16x32_bf16 v[28:31], v[112:115], a[240:243], v[28:31]
    v_mfma_f32_16x16x32_bf16 v[16:19], v[116:119], a[52:55], v[16:19]
    v_mfma_f32_16x16x32_bf16 v[20:23], v[116:119], a[116:119], v[20:23]
    v_mfma_f32_16x16x32_bf16 v[24:27], v[116:119], a[180:183], v[24:27]
    v_mfma_f32_16x16x32_bf16 v[28:31], v[116:119], a[244:247], v[28:31]
    v_mfma_f32_16x16x32_bf16 v[16:19], v[120:123], a[56:59], v[16:19]
    v_mfma_f32_16x16x32_bf16 v[20:23], v[120:123], a[120:123], v[20:23]
    v_mfma_f32_16x16x32_bf16 v[24:27], v[120:123], a[184:187], v[24:27]
    v_mfma_f32_16x16x32_bf16 v[28:31], v[120:123], a[248:251], v[28:31]
    v_mfma_f32_16x16x32_bf16 v[16:19], v[124:127], a[60:63], v[16:19]
    v_mfma_f32_16x16x32_bf16 v[20:23], v[124:127], a[124:127], v[20:23]
    v_mfma_f32_16x16x32_bf16 v[24:27], v[124:127], a[188:191], v[24:27]
    v_mfma_f32_16x16x32_bf16 v[28:31], v[124:127], a[252:255], v[28:31]
    s_lshr_b32 s13, s12, 8
    s_lshl_b32 s13, s13, 24
    s_and_b32 s14, s12, 255
    s_lshl_b32 s14, s14, 5
    s_add_u32 s13, s13, s14
    s_add_u32 s13, s13, 33554432
    v_add_u32 v8, s6, v4
    v_lshlrev_b32 v8, 13, v8
    v_lshl_add_u32 v8, v3, 3, v8
    s_nop 7
    v_cvt_pk_bf16_f32 v32, v16, v17
    v_cvt_pk_bf16_f32 v33, v18, v19
    buffer_store_dwordx2 v[32:33], v8, s[48:51], s13 offen offset:0
    v_cvt_pk_bf16_f32 v34, v20, v21
    v_cvt_pk_bf16_f32 v35, v22, v23
    v_add_u32 v8, 131072, v8
    buffer_store_dwordx2 v[34:35], v8, s[48:51], s13 offen
    v_cvt_pk_bf16_f32 v36, v24, v25
    v_cvt_pk_bf16_f32 v37, v26, v27
    v_add_u32 v8, 131072, v8
    buffer_store_dwordx2 v[36:37], v8, s[48:51], s13 offen
    v_cvt_pk_bf16_f32 v38, v28, v29
    v_cvt_pk_bf16_f32 v39, v30, v31
    v_add_u32 v8, 131072, v8
    buffer_store_dwordx2 v[38:39], v8, s[48:51], s13 offen
    s_branch k2_e_3
k2_v_2:
    v_mfma_f32_16x16x32_bf16 v[16:19], a[0:3], v[64:67], 0
    v_mfma_f32_16x16x32_bf16 v[20:23], a[64:67], v[64:67], 0
    v_mfma_f32_16x16x32_bf16 v[24:27], a[128:131], v[64:67], 0
    v_mfma_f32_16x16x32_bf16 v[28:31], a[192:195], v[64:67], 0
    v_mfma_f32_16x16x32_bf16 v[16:19], a[4:7], v[68:71], v[16:19]
    v_mfma_f32_16x16x32_bf16 v[20:23], a[68:71], v[68:71], v[20:23]
    v_mfma_f32_16x16x32_bf16 v[24:27], a[132:135], v[68:71], v[24:27]
    v_mfma_f32_16x16x32_bf16 v[28:31], a[196:199], v[68:71], v[28:31]
    v_mfma_f32_16x16x32_bf16 v[16:19], a[8:11], v[72:75], v[16:19]
    v_mfma_f32_16x16x32_bf16 v[20:23], a[72:75], v[72:75], v[20:23]
    v_mfma_f32_16x16x32_bf16 v[24:27], a[136:139], v[72:75], v[24:27]
    v_mfma_f32_16x16x32_bf16 v[28:31], a[200:203], v[72:75], v[28:31]
    v_mfma_f32_16x16x32_bf16 v[16:19], a[12:15], v[76:79], v[16:19]
    v_mfma_f32_16x16x32_bf16 v[20:23], a[76:79], v[76:79], v[20:23]
    v_mfma_f32_16x16x32_bf16 v[24:27], a[140:143], v[76:79], v[24:27]
    v_mfma_f32_16x16x32_bf16 v[28:31], a[204:207], v[76:79], v[28:31]
    v_mfma_f32_16x16x32_bf16 v[16:19], a[16:19], v[80:83], v[16:19]
    v_mfma_f32_16x16x32_bf16 v[20:23], a[80:83], v[80:83], v[20:23]
    v_mfma_f32_16x16x32_bf16 v[24:27], a[144:147], v[80:83], v[24:27]
    v_mfma_f32_16x16x32_bf16 v[28:31], a[208:211], v[80:83], v[28:31]
    v_mfma_f32_16x16x32_bf16 v[16:19], a[20:23], v[84:87], v[16:19]
    v_mfma_f32_16x16x32_bf16 v[20:23], a[84:87], v[84:87], v[20:23]
    v_mfma_f32_16x16x32_bf16 v[24:27], a[148:151], v[84:87], v[24:27]
    v_mfma_f32_16x16x32_bf16 v[28:31], a[212:215], v[84:87], v[28:31]
    v_mfma_f32_16x16x32_bf16 v[16:19], a[24:27], v[88:91], v[16:19]
    v_mfma_f32_16x16x32_bf16 v[20:23], a[88:91], v[88:91], v[20:23]
    v_mfma_f32_16x16x32_bf16 v[24:27], a[152:155], v[88:91], v[24:27]
    v_mfma_f32_16x16x32_bf16 v[28:31], a[216:219], v[88:91], v[28:31]
    v_mfma_f32_16x16x32_bf16 v[16:19], a[28:31], v[92:95], v[16:19]
    v_mfma_f32_16x16x32_bf16 v[20:23], a[92:95], v[92:95], v[20:23]
    v_mfma_f32_16x16x32_bf16 v[24:27], a[156:159], v[92:95], v[24:27]
    v_mfma_f32_16x16x32_bf16 v[28:31], a[220:223], v[92:95], v[28:31]
    v_mfma_f32_16x16x32_bf16 v[16:19], a[32:35], v[96:99], v[16:19]
    v_mfma_f32_16x16x32_bf16 v[20:23], a[96:99], v[96:99], v[20:23]
    v_mfma_f32_16x16x32_bf16 v[24:27], a[160:163], v[96:99], v[24:27]
    v_mfma_f32_16x16x32_bf16 v[28:31], a[224:227], v[96:99], v[28:31]
    v_mfma_f32_16x16x32_bf16 v[16:19], a[36:39], v[100:103], v[16:19]
    v_mfma_f32_16x16x32_bf16 v[20:23], a[100:103], v[100:103], v[20:23]
    v_mfma_f32_16x16x32_bf16 v[24:27], a[164:167], v[100:103], v[24:27]
    v_mfma_f32_16x16x32_bf16 v[28:31], a[228:231], v[100:103], v[28:31]
    v_mfma_f32_16x16x32_bf16 v[16:19], a[40:43], v[104:107], v[16:19]
    v_mfma_f32_16x16x32_bf16 v[20:23], a[104:107], v[104:107], v[20:23]
    v_mfma_f32_16x16x32_bf16 v[24:27], a[168:171], v[104:107], v[24:27]
    v_mfma_f32_16x16x32_bf16 v[28:31], a[232:235], v[104:107], v[28:31]
    v_mfma_f32_16x16x32_bf16 v[16:19], a[44:47], v[108:111], v[16:19]
    v_mfma_f32_16x16x32_bf16 v[20:23], a[108:111], v[108:111], v[20:23]
    v_mfma_f32_16x16x32_bf16 v[24:27], a[172:175], v[108:111], v[24:27]
    v_mfma_f32_16x16x32_bf16 v[28:31], a[236:239], v[108:111], v[28:31]
    v_mfma_f32_16x16x32_bf16 v[16:19], a[48:51], v[112:115], v[16:19]
    v_mfma_f32_16x16x32_bf16 v[20:23], a[112:115], v[112:115], v[20:23]
    v_mfma_f32_16x16x32_bf16 v[24:27], a[176:179], v[112:115], v[24:27]
    v_mfma_f32_16x16x32_bf16 v[28:31], a[240:243], v[112:115], v[28:31]
    v_mfma_f32_16x16x32_bf16 v[16:19], a[52:55], v[116:119], v[16:19]
    v_mfma_f32_16x16x32_bf16 v[20:23], a[116:119], v[116:119], v[20:23]
    v_mfma_f32_16x16x32_bf16 v[24:27], a[180:183], v[116:119], v[24:27]
    v_mfma_f32_16x16x32_bf16 v[28:31], a[244:247], v[116:119], v[28:31]
    v_mfma_f32_16x16x32_bf16 v[16:19], a[56:59], v[120:123], v[16:19]
    v_mfma_f32_16x16x32_bf16 v[20:23], a[120:123], v[120:123], v[20:23]
    v_mfma_f32_16x16x32_bf16 v[24:27], a[184:187], v[120:123], v[24:27]
    v_mfma_f32_16x16x32_bf16 v[28:31], a[248:251], v[120:123], v[28:31]
    v_mfma_f32_16x16x32_bf16 v[16:19], a[60:63], v[124:127], v[16:19]
    v_mfma_f32_16x16x32_bf16 v[20:23], a[124:127], v[124:127], v[20:23]
    v_mfma_f32_16x16x32_bf16 v[24:27], a[188:191], v[124:127], v[24:27]
    v_mfma_f32_16x16x32_bf16 v[28:31], a[252:255], v[124:127], v[28:31]
    s_sub_u32 s13, s12, 512
    s_lshl_b32 s13, s13, 16
    s_lshl_b32 s14, s6, 1
    s_add_u32 s13, s13, s14
    s_add_u32 s13, s13, 67108864
    v_lshlrev_b32 v8, 12, v4
    v_lshl_add_u32 v8, v3, 3, v8
    s_nop 7
    v_cvt_pk_bf16_f32 v32, v16, v17
    v_cvt_pk_bf16_f32 v33, v18, v19
    buffer_store_dwordx2 v[32:33], v8, s[48:51], s13 offen offset:0
    v_cvt_pk_bf16_f32 v34, v20, v21
    v_cvt_pk_bf16_f32 v35, v22, v23
    buffer_store_dwordx2 v[34:35], v8, s[48:51], s13 offen offset:32
    v_cvt_pk_bf16_f32 v36, v24, v25
    v_cvt_pk_bf16_f32 v37, v26, v27
    buffer_store_dwordx2 v[36:37], v8, s[48:51], s13 offen offset:64
    v_cvt_pk_bf16_f32 v38, v28, v29
    v_cvt_pk_bf16_f32 v39, v30, v31
    buffer_store_dwordx2 v[38:39], v8, s[48:51], s13 offen offset:96
k2_e_3:
    s_add_u32 s9, s9, 1
    s_add_u32 s11, s11, 16384
    s_add_u32 s10, s11, 0
    buffer_load_dwordx4 v[64:67], v6, s[48:51], s10 offen offset:0
    buffer_load_dwordx4 v[68:71], v6, s[48:51], s10 offen offset:1024
    buffer_load_dwordx4 v[72:75], v6, s[48:51], s10 offen offset:2048
    buffer_load_dwordx4 v[76:79], v6, s[48:51], s10 offen offset:3072
    s_add_u32 s10, s11, 4096
    buffer_load_dwordx4 v[80:83], v6, s[48:51], s10 offen offset:0
    buffer_load_dwordx4 v[84:87], v6, s[48:51], s10 offen offset:1024
    buffer_load_dwordx4 v[88:91], v6, s[48:51], s10 offen offset:2048
    buffer_load_dwordx4 v[92:95], v6, s[48:51], s10 offen offset:3072
    s_add_u32 s10, s11, 8192
    buffer_load_dwordx4 v[96:99], v6, s[48:51], s10 offen offset:0
    buffer_load_dwordx4 v[100:103], v6, s[48:51], s10 offen offset:1024
    buffer_load_dwordx4 v[104:107], v6, s[48:51], s10 offen offset:2048
    buffer_load_dwordx4 v[108:111], v6, s[48:51], s10 offen offset:3072
    s_add_u32 s10, s11, 12288
    buffer_load_dwordx4 v[112:115], v6, s[48:51], s10 offen offset:0
    buffer_load_dwordx4 v[116:119], v6, s[48:51], s10 offen offset:1024
    buffer_load_dwordx4 v[120:123], v6, s[48:51], s10 offen offset:2048
    buffer_load_dwordx4 v[124:127], v6, s[48:51], s10 offen offset:3072
    s_waitcnt vmcnt(16)
    s_add_u32 s12, s8, s9
    s_cmp_ge_u32 s12, 512
    s_cbranch_scc1 k2_v_4
    v_mfma_f32_16x16x32_bf16 v[16:19], v[128:131], a[0:3], 0
    v_mfma_f32_16x16x32_bf16 v[20:23], v[128:131], a[64:67], 0
    v_mfma_f32_16x16x32_bf16 v[24:27], v[128:131], a[128:131], 0
    v_mfma_f32_16x16x32_bf16 v[28:31], v[128:131], a[192:195], 0
    v_mfma_f32_16x16x32_bf16 v[16:19], v[132:135], a[4:7], v[16:19]
    v_mfma_f32_16x16x32_bf16 v[20:23], v[132:135], a[68:71], v[20:23]
    v_mfma_f32_16x16x32_bf16 v[24:27], v[132:135], a[132:135], v[24:27]
    v_mfma_f32_16x16x32_bf16 v[28:31], v[132:135], a[196:199], v[28:31]
    v_mfma_f32_16x16x32_bf16 v[16:19], v[136:139], a[8:11], v[16:19]
    v_mfma_f32_16x16x32_bf16 v[20:23], v[136:139], a[72:75], v[20:23]
    v_mfma_f32_16x16x32_bf16 v[24:27], v[136:139], a[136:139], v[24:27]
    v_mfma_f32_16x16x32_bf16 v[28:31], v[136:139], a[200:203], v[28:31]
    v_mfma_f32_16x16x32_bf16 v[16:19], v[140:143], a[12:15], v[16:19]
    v_mfma_f32_16x16x32_bf16 v[20:23], v[140:143], a[76:79], v[20:23]
    v_mfma_f32_16x16x32_bf16 v[24:27], v[140:143], a[140:143], v[24:27]
    v_mfma_f32_16x16x32_bf16 v[28:31], v[140:143], a[204:207], v[28:31]
    v_mfma_f32_16x16x32_bf16 v[16:19], v[144:147], a[16:19], v[16:19]
    v_mfma_f32_16x16x32_bf16 v[20:23], v[144:147], a[80:83], v[20:23]
    v_mfma_f32_16x16x32_bf16 v[24:27], v[144:147], a[144:147], v[24:27]
    v_mfma_f32_16x16x32_bf16 v[28:31], v[144:147], a[208:211], v[28:31]
    v_mfma_f32_16x16x32_bf16 v[16:19], v[148:151], a[20:23], v[16:19]
    v_mfma_f32_16x16x32_bf16 v[20:23], v[148:151], a[84:87], v[20:23]
    v_mfma_f32_16x16x32_bf16 v[24:27], v[148:151], a[148:151], v[24:27]
    v_mfma_f32_16x16x32_bf16 v[28:31], v[148:151], a[212:215], v[28:31]
    v_mfma_f32_16x16x32_bf16 v[16:19], v[152:155], a[24:27], v[16:19]
    v_mfma_f32_16x16x32_bf16 v[20:23], v[152:155], a[88:91], v[20:23]
    v_mfma_f32_16x16x32_bf16 v[24:27], v[152:155], a[152:155], v[24:27]
    v_mfma_f32_16x16x32_bf16 v[28:31], v[152:155], a[216:219], v[28:31]
    v_mfma_f32_16x16x32_bf16 v[16:19], v[156:159], a[28:31], v[16:19]
    v_mfma_f32_16x16x32_bf16 v[20:23], v[156:159], a[92:95], v[20:23]
    v_mfma_f32_16x16x32_bf16 v[24:27], v[156:159], a[156:159], v[24:27]
    v_mfma_f32_16x16x32_bf16 v[28:31], v[156:159], a[220:223], v[28:31]
    v_mfma_f32_16x16x32_bf16 v[16:19], v[160:163], a[32:35], v[16:19]
    v_mfma_f32_16x16x32_bf16 v[20:23], v[160:163], a[96:99], v[20:23]
    v_mfma_f32_16x16x32_bf16 v[24:27], v[160:163], a[160:163], v[24:27]
    v_mfma_f32_16x16x32_bf16 v[28:31], v[160:163], a[224:227], v[28:31]
    v_mfma_f32_16x16x32_bf16 v[16:19], v[164:167], a[36:39], v[16:19]
    v_mfma_f32_16x16x32_bf16 v[20:23], v[164:167], a[100:103], v[20:23]
    v_mfma_f32_16x16x32_bf16 v[24:27], v[164:167], a[164:167], v[24:27]
    v_mfma_f32_16x16x32_bf16 v[28:31], v[164:167], a[228:231], v[28:31]
    v_mfma_f32_16x16x32_bf16 v[16:19], v[168:171], a[40:43], v[16:19]
    v_mfma_f32_16x16x32_bf16 v[20:23], v[168:171], a[104:107], v[20:23]
    v_mfma_f32_16x16x32_bf16 v[24:27], v[168:171], a[168:171], v[24:27]
    v_mfma_f32_16x16x32_bf16 v[28:31], v[168:171], a[232:235], v[28:31]
    v_mfma_f32_16x16x32_bf16 v[16:19], v[172:175], a[44:47], v[16:19]
    v_mfma_f32_16x16x32_bf16 v[20:23], v[172:175], a[108:111], v[20:23]
    v_mfma_f32_16x16x32_bf16 v[24:27], v[172:175], a[172:175], v[24:27]
    v_mfma_f32_16x16x32_bf16 v[28:31], v[172:175], a[236:239], v[28:31]
    v_mfma_f32_16x16x32_bf16 v[16:19], v[176:179], a[48:51], v[16:19]
    v_mfma_f32_16x16x32_bf16 v[20:23], v[176:179], a[112:115], v[20:23]
    v_mfma_f32_16x16x32_bf16 v[24:27], v[176:179], a[176:179], v[24:27]
    v_mfma_f32_16x16x32_bf16 v[28:31], v[176:179], a[240:243], v[28:31]
    v_mfma_f32_16x16x32_bf16 v[16:19], v[180:183], a[52:55], v[16:19]
    v_mfma_f32_16x16x32_bf16 v[20:23], v[180:183], a[116:119], v[20:23]
    v_mfma_f32_16x16x32_bf16 v[24:27], v[180:183], a[180:183], v[24:27]
    v_mfma_f32_16x16x32_bf16 v[28:31], v[180:183], a[244:247], v[28:31]
    v_mfma_f32_16x16x32_bf16 v[16:19], v[184:187], a[56:59], v[16:19]
    v_mfma_f32_16x16x32_bf16 v[20:23], v[184:187], a[120:123], v[20:23]
    v_mfma_f32_16x16x32_bf16 v[24:27], v[184:187], a[184:187], v[24:27]
    v_mfma_f32_16x16x32_bf16 v[28:31], v[184:187], a[248:251], v[28:31]
    v_mfma_f32_16x16x32_bf16 v[16:19], v[188:191], a[60:63], v[16:19]
    v_mfma_f32_16x16x32_bf16 v[20:23], v[188:191], a[124:127], v[20:23]
    v_mfma_f32_16x16x32_bf16 v[24:27], v[188:191], a[188:191], v[24:27]
    v_mfma_f32_16x16x32_bf16 v[28:31], v[188:191], a[252:255], v[28:31]
    s_lshr_b32 s13, s12, 8
    s_lshl_b32 s13, s13, 24
    s_and_b32 s14, s12, 255
    s_lshl_b32 s14, s14, 5
    s_add_u32 s13, s13, s14
    s_add_u32 s13, s13, 33554432
    v_add_u32 v8, s6, v4
    v_lshlrev_b32 v8, 13, v8
    v_lshl_add_u32 v8, v3, 3, v8
    s_nop 7
    v_cvt_pk_bf16_f32 v32, v16, v17
    v_cvt_pk_bf16_f32 v33, v18, v19
    buffer_store_dwordx2 v[32:33], v8, s[48:51], s13 offen offset:0
    v_cvt_pk_bf16_f32 v34, v20, v21
    v_cvt_pk_bf16_f32 v35, v22, v23
    v_add_u32 v8, 131072, v8
    buffer_store_dwordx2 v[34:35], v8, s[48:51], s13 offen
    v_cvt_pk_bf16_f32 v36, v24, v25
    v_cvt_pk_bf16_f32 v37, v26, v27
    v_add_u32 v8, 131072, v8
    buffer_store_dwordx2 v[36:37], v8, s[48:51], s13 offen
    v_cvt_pk_bf16_f32 v38, v28, v29
    v_cvt_pk_bf16_f32 v39, v30, v31
    v_add_u32 v8, 131072, v8
    buffer_store_dwordx2 v[38:39], v8, s[48:51], s13 offen
    s_branch k2_e_5
k2_v_4:
    v_mfma_f32_16x16x32_bf16 v[16:19], a[0:3], v[128:131], 0
    v_mfma_f32_16x16x32_bf16 v[20:23], a[64:67], v[128:131], 0
    v_mfma_f32_16x16x32_bf16 v[24:27], a[128:131], v[128:131], 0
    v_mfma_f32_16x16x32_bf16 v[28:31], a[192:195], v[128:131], 0
    v_mfma_f32_16x16x32_bf16 v[16:19], a[4:7], v[132:135], v[16:19]
    v_mfma_f32_16x16x32_bf16 v[20:23], a[68:71], v[132:135], v[20:23]
    v_mfma_f32_16x16x32_bf16 v[24:27], a[132:135], v[132:135], v[24:27]
    v_mfma_f32_16x16x32_bf16 v[28:31], a[196:199], v[132:135], v[28:31]
    v_mfma_f32_16x16x32_bf16 v[16:19], a[8:11], v[136:139], v[16:19]
    v_mfma_f32_16x16x32_bf16 v[20:23], a[72:75], v[136:139], v[20:23]
    v_mfma_f32_16x16x32_bf16 v[24:27], a[136:139], v[136:139], v[24:27]
    v_mfma_f32_16x16x32_bf16 v[28:31], a[200:203], v[136:139], v[28:31]
    v_mfma_f32_16x16x32_bf16 v[16:19], a[12:15], v[140:143], v[16:19]
    v_mfma_f32_16x16x32_bf16 v[20:23], a[76:79], v[140:143], v[20:23]
    v_mfma_f32_16x16x32_bf16 v[24:27], a[140:143], v[140:143], v[24:27]
    v_mfma_f32_16x16x32_bf16 v[28:31], a[204:207], v[140:143], v[28:31]
    v_mfma_f32_16x16x32_bf16 v[16:19], a[16:19], v[144:147], v[16:19]
    v_mfma_f32_16x16x32_bf16 v[20:23], a[80:83], v[144:147], v[20:23]
    v_mfma_f32_16x16x32_bf16 v[24:27], a[144:147], v[144:147], v[24:27]
    v_mfma_f32_16x16x32_bf16 v[28:31], a[208:211], v[144:147], v[28:31]
    v_mfma_f32_16x16x32_bf16 v[16:19], a[20:23], v[148:151], v[16:19]
    v_mfma_f32_16x16x32_bf16 v[20:23], a[84:87], v[148:151], v[20:23]
    v_mfma_f32_16x16x32_bf16 v[24:27], a[148:151], v[148:151], v[24:27]
    v_mfma_f32_16x16x32_bf16 v[28:31], a[212:215], v[148:151], v[28:31]
    v_mfma_f32_16x16x32_bf16 v[16:19], a[24:27], v[152:155], v[16:19]
    v_mfma_f32_16x16x32_bf16 v[20:23], a[88:91], v[152:155], v[20:23]
    v_mfma_f32_16x16x32_bf16 v[24:27], a[152:155], v[152:155], v[24:27]
    v_mfma_f32_16x16x32_bf16 v[28:31], a[216:219], v[152:155], v[28:31]
    v_mfma_f32_16x16x32_bf16 v[16:19], a[28:31], v[156:159], v[16:19]
    v_mfma_f32_16x16x32_bf16 v[20:23], a[92:95], v[156:159], v[20:23]
    v_mfma_f32_16x16x32_bf16 v[24:27], a[156:159], v[156:159], v[24:27]
    v_mfma_f32_16x16x32_bf16 v[28:31], a[220:223], v[156:159], v[28:31]
    v_mfma_f32_16x16x32_bf16 v[16:19], a[32:35], v[160:163], v[16:19]
    v_mfma_f32_16x16x32_bf16 v[20:23], a[96:99], v[160:163], v[20:23]
    v_mfma_f32_16x16x32_bf16 v[24:27], a[160:163], v[160:163], v[24:27]
    v_mfma_f32_16x16x32_bf16 v[28:31], a[224:227], v[160:163], v[28:31]
    v_mfma_f32_16x16x32_bf16 v[16:19], a[36:39], v[164:167], v[16:19]
    v_mfma_f32_16x16x32_bf16 v[20:23], a[100:103], v[164:167], v[20:23]
    v_mfma_f32_16x16x32_bf16 v[24:27], a[164:167], v[164:167], v[24:27]
    v_mfma_f32_16x16x32_bf16 v[28:31], a[228:231], v[164:167], v[28:31]
    v_mfma_f32_16x16x32_bf16 v[16:19], a[40:43], v[168:171], v[16:19]
    v_mfma_f32_16x16x32_bf16 v[20:23], a[104:107], v[168:171], v[20:23]
    v_mfma_f32_16x16x32_bf16 v[24:27], a[168:171], v[168:171], v[24:27]
    v_mfma_f32_16x16x32_bf16 v[28:31], a[232:235], v[168:171], v[28:31]
    v_mfma_f32_16x16x32_bf16 v[16:19], a[44:47], v[172:175], v[16:19]
    v_mfma_f32_16x16x32_bf16 v[20:23], a[108:111], v[172:175], v[20:23]
    v_mfma_f32_16x16x32_bf16 v[24:27], a[172:175], v[172:175], v[24:27]
    v_mfma_f32_16x16x32_bf16 v[28:31], a[236:239], v[172:175], v[28:31]
    v_mfma_f32_16x16x32_bf16 v[16:19], a[48:51], v[176:179], v[16:19]
    v_mfma_f32_16x16x32_bf16 v[20:23], a[112:115], v[176:179], v[20:23]
    v_mfma_f32_16x16x32_bf16 v[24:27], a[176:179], v[176:179], v[24:27]
    v_mfma_f32_16x16x32_bf16 v[28:31], a[240:243], v[176:179], v[28:31]
    v_mfma_f32_16x16x32_bf16 v[16:19], a[52:55], v[180:183], v[16:19]
    v_mfma_f32_16x16x32_bf16 v[20:23], a[116:119], v[180:183], v[20:23]
    v_mfma_f32_16x16x32_bf16 v[24:27], a[180:183], v[180:183], v[24:27]
    v_mfma_f32_16x16x32_bf16 v[28:31], a[244:247], v[180:183], v[28:31]
    v_mfma_f32_16x16x32_bf16 v[16:19], a[56:59], v[184:187], v[16:19]
    v_mfma_f32_16x16x32_bf16 v[20:23], a[120:123], v[184:187], v[20:23]
    v_mfma_f32_16x16x32_bf16 v[24:27], a[184:187], v[184:187], v[24:27]
    v_mfma_f32_16x16x32_bf16 v[28:31], a[248:251], v[184:187], v[28:31]
    v_mfma_f32_16x16x32_bf16 v[16:19], a[60:63], v[188:191], v[16:19]
    v_mfma_f32_16x16x32_bf16 v[20:23], a[124:127], v[188:191], v[20:23]
    v_mfma_f32_16x16x32_bf16 v[24:27], a[188:191], v[188:191], v[24:27]
    v_mfma_f32_16x16x32_bf16 v[28:31], a[252:255], v[188:191], v[28:31]
    s_sub_u32 s13, s12, 512
    s_lshl_b32 s13, s13, 16
    s_lshl_b32 s14, s6, 1
    s_add_u32 s13, s13, s14
    s_add_u32 s13, s13, 67108864
    v_lshlrev_b32 v8, 12, v4
    v_lshl_add_u32 v8, v3, 3, v8
    s_nop 7
    v_cvt_pk_bf16_f32 v32, v16, v17
    v_cvt_pk_bf16_f32 v33, v18, v19
    buffer_store_dwordx2 v[32:33], v8, s[48:51], s13 offen offset:0
    v_cvt_pk_bf16_f32 v34, v20, v21
    v_cvt_pk_bf16_f32 v35, v22, v23
    buffer_store_dwordx2 v[34:35], v8, s[48:51], s13 offen offset:32
    v_cvt_pk_bf16_f32 v36, v24, v25
    v_cvt_pk_bf16_f32 v37, v26, v27
    buffer_store_dwordx2 v[36:37], v8, s[48:51], s13 offen offset:64
    v_cvt_pk_bf16_f32 v38, v28, v29
    v_cvt_pk_bf16_f32 v39, v30, v31
    buffer_store_dwordx2 v[38:39], v8, s[48:51], s13 offen offset:96
k2_e_5:
    s_add_u32 s9, s9, 1
    s_cmp_lt_u32 s9, 24
    s_cbranch_scc1 k2_loop_1
k2_end:
    s_endpgm
    .globl k3_kernel
    .p2align 8
    .type k3_kernel,@function
k3_kernel:
    s_cmp_ge_u32 s2, 256
    s_cbranch_scc1 k3_end
    s_load_dwordx2 s[32:33], s[0:1], 112
    s_load_dwordx2 s[34:35], s[0:1], 8
    v_lshrrev_b32 v1, 6, v0
    v_and_b32 v2, 63, v0
    v_readfirstlane_b32 s3, v1
    s_waitcnt lgkmcnt(0)
    s_mov_b32 s48, s32
    s_and_b32 s49, s33, 0xffff
    s_mov_b32 s50, 268435456
    s_mov_b32 s51, 0x00020000
    s_mov_b32 s52, s34
    s_and_b32 s53, s35, 0xffff
    s_mov_b32 s54, 8192
    s_mov_b32 s55, 0x00020000
    v_lshrrev_b32 v3, 4, v2
    v_and_b32 v4, 15, v2
    s_and_b32 s4, s2, 7
    s_cmp_lg_u32 s4, 0
    s_cbranch_scc1 k3_mlp
    s_lshr_b32 s5, s2, 3
    s_getreg_b32 s6, hwreg(HW_REG_XCC_ID)
    s_and_b32 s6, s6, 15
    s_add_u32 s6, s6, 1
    v_mov_b32 v5, s6
    s_lshl_b32 s7, s5, 2
    v_mov_b32 v6, s7
    v_add_u32 v6, 119570432, v6
    buffer_store_dword v5, v6, s[48:51], 0 offen sc1
    v_lshlrev_b32 v6, 2, v2
    v_and_b32 v6, 127, v6
    v_add_u32 v6, 119570432, v6
idp_6:
    buffer_load_dword v5, v6, s[48:51], 0 offen sc1
    s_waitcnt vmcnt(0)
    v_cmp_eq_u32 vcc, 0, v5
    s_cmp_lg_u64 vcc, 0
    s_cbranch_scc1 idp_6
    v_cmp_ne_u32 vcc, s6, v5
    s_cmp_lg_u64 vcc, 0
    s_cselect_b32 s60, 1, 0
    s_mul_i32 s8, s3, 6
    v_lshlrev_b32 v6, 4, v2
    s_add_u32 s9, s8, 0
    s_lshr_b32 s10, s9, 3
    s_lshl_b32 s10, s10, 8
    s_and_b32 s11, s9, 7
    s_add_u32 s10, s10, s11
    s_lshl_b32 s11, s5, 3
    s_add_u32 s10, s10, s11
    s_lshl_b32 s10, s10, 14
    s_add_u32 s10, s10, 4194304
    s_add_u32 s11, s10, 0
    buffer_load_dwordx4 a[0:3], v6, s[48:51], s11 offen offset:0
    buffer_load_dwordx4 a[4:7], v6, s[48:51], s11 offen offset:1024
    buffer_load_dwordx4 a[8:11], v6, s[48:51], s11 offen offset:2048
    buffer_load_dwordx4 a[12:15], v6, s[48:51], s11 offen offset:3072
    s_add_u32 s11, s10, 4096
    buffer_load_dwordx4 a[16:19], v6, s[48:51], s11 offen offset:0
    buffer_load_dwordx4 a[20:23], v6, s[48:51], s11 offen offset:1024
    buffer_load_dwordx4 a[24:27], v6, s[48:51], s11 offen offset:2048
    buffer_load_dwordx4 a[28:31], v6, s[48:51], s11 offen offset:3072
    s_add_u32 s11, s10, 8192
    buffer_load_dwordx4 a[32:35], v6, s[48:51], s11 offen offset:0
    buffer_load_dwordx4 a[36:39], v6, s[48:51], s11 offen offset:1024
    buffer_load_dwordx4 a[40:43], v6, s[48:51], s11 offen offset:2048
    buffer_load_dwordx4 a[44:47], v6, s[48:51], s11 offen offset:3072
    s_add_u32 s11, s10, 12288
    buffer_load_dwordx4 a[48:51], v6, s[48:51], s11 offen offset:0
    buffer_load_dwordx4 a[52:55], v6, s[48:51], s11 offen offset:1024
    buffer_load_dwordx4 a[56:59], v6, s[48:51], s11 offen offset:2048
    buffer_load_dwordx4 a[60:63], v6, s[48:51], s11 offen offset:3072
    s_add_u32 s9, s8, 1
    s_lshr_b32 s10, s9, 3
    s_lshl_b32 s10, s10, 8
    s_and_b32 s11, s9, 7
    s_add_u32 s10, s10, s11
    s_lshl_b32 s11, s5, 3
    s_add_u32 s10, s10, s11
    s_lshl_b32 s10, s10, 14
    s_add_u32 s10, s10, 4194304
    s_add_u32 s11, s10, 0
    buffer_load_dwordx4 a[64:67], v6, s[48:51], s11 offen offset:0
    buffer_load_dwordx4 a[68:71], v6, s[48:51], s11 offen offset:1024
    buffer_load_dwordx4 a[72:75], v6, s[48:51], s11 offen offset:2048
    buffer_load_dwordx4 a[76:79], v6, s[48:51], s11 offen offset:3072
    s_add_u32 s11, s10, 4096
    buffer_load_dwordx4 a[80:83], v6, s[48:51], s11 offen offset:0
    buffer_load_dwordx4 a[84:87], v6, s[48:51], s11 offen offset:1024
    buffer_load_dwordx4 a[88:91], v6, s[48:51], s11 offen offset:2048
    buffer_load_dwordx4 a[92:95], v6, s[48:51], s11 offen offset:3072
    s_add_u32 s11, s10, 8192
    buffer_load_dwordx4 a[96:99], v6, s[48:51], s11 offen offset:0
    buffer_load_dwordx4 a[100:103], v6, s[48:51], s11 offen offset:1024
    buffer_load_dwordx4 a[104:107], v6, s[48:51], s11 offen offset:2048
    buffer_load_dwordx4 a[108:111], v6, s[48:51], s11 offen offset:3072
    s_add_u32 s11, s10, 12288
    buffer_load_dwordx4 a[112:115], v6, s[48:51], s11 offen offset:0
    buffer_load_dwordx4 a[116:119], v6, s[48:51], s11 offen offset:1024
    buffer_load_dwordx4 a[120:123], v6, s[48:51], s11 offen offset:2048
    buffer_load_dwordx4 a[124:127], v6, s[48:51], s11 offen offset:3072
    s_add_u32 s9, s8, 2
    s_lshr_b32 s10, s9, 3
    s_lshl_b32 s10, s10, 8
    s_and_b32 s11, s9, 7
    s_add_u32 s10, s10, s11
    s_lshl_b32 s11, s5, 3
    s_add_u32 s10, s10, s11
    s_lshl_b32 s10, s10, 14
    s_add_u32 s10, s10, 4194304
    s_add_u32 s11, s10, 0
    buffer_load_dwordx4 a[128:131], v6, s[48:51], s11 offen offset:0
    buffer_load_dwordx4 a[132:135], v6, s[48:51], s11 offen offset:1024
    buffer_load_dwordx4 a[136:139], v6, s[48:51], s11 offen offset:2048
    buffer_load_dwordx4 a[140:143], v6, s[48:51], s11 offen offset:3072
    s_add_u32 s11, s10, 4096
    buffer_load_dwordx4 a[144:147], v6, s[48:51], s11 offen offset:0
    buffer_load_dwordx4 a[148:151], v6, s[48:51], s11 offen offset:1024
    buffer_load_dwordx4 a[152:155], v6, s[48:51], s11 offen offset:2048
    buffer_load_dwordx4 a[156:159], v6, s[48:51], s11 offen offset:3072
    s_add_u32 s11, s10, 8192
    buffer_load_dwordx4 a[160:163], v6, s[48:51], s11 offen offset:0
    buffer_load_dwordx4 a[164:167], v6, s[48:51], s11 offen offset:1024
    buffer_load_dwordx4 a[168:171], v6, s[48:51], s11 offen offset:2048
    buffer_load_dwordx4 a[172:175], v6, s[48:51], s11 offen offset:3072
    s_add_u32 s11, s10, 12288
    buffer_load_dwordx4 a[176:179], v6, s[48:51], s11 offen offset:0
    buffer_load_dwordx4 a[180:183], v6, s[48:51], s11 offen offset:1024
    buffer_load_dwordx4 a[184:187], v6, s[48:51], s11 offen offset:2048
    buffer_load_dwordx4 a[188:191], v6, s[48:51], s11 offen offset:3072
    s_add_u32 s9, s8, 3
    s_lshr_b32 s10, s9, 3
    s_lshl_b32 s10, s10, 8
    s_and_b32 s11, s9, 7
    s_add_u32 s10, s10, s11
    s_lshl_b32 s11, s5, 3
    s_add_u32 s10, s10, s11
    s_lshl_b32 s10, s10, 14
    s_add_u32 s10, s10, 4194304
    s_add_u32 s11, s10, 0
    buffer_load_dwordx4 a[192:195], v6, s[48:51], s11 offen offset:0
    buffer_load_dwordx4 a[196:199], v6, s[48:51], s11 offen offset:1024
    buffer_load_dwordx4 a[200:203], v6, s[48:51], s11 offen offset:2048
    buffer_load_dwordx4 a[204:207], v6, s[48:51], s11 offen offset:3072
    s_add_u32 s11, s10, 4096
    buffer_load_dwordx4 a[208:211], v6, s[48:51], s11 offen offset:0
    buffer_load_dwordx4 a[212:215], v6, s[48:51], s11 offen offset:1024
    buffer_load_dwordx4 a[216:219], v6, s[48:51], s11 offen offset:2048
    buffer_load_dwordx4 a[220:223], v6, s[48:51], s11 offen offset:3072
    s_add_u32 s11, s10, 8192
    buffer_load_dwordx4 a[224:227], v6, s[48:51], s11 offen offset:0
    buffer_load_dwordx4 a[228:231], v6, s[48:51], s11 offen offset:1024
    buffer_load_dwordx4 a[232:235], v6, s[48:51], s11 offen offset:2048
    buffer_load_dwordx4 a[236:239], v6, s[48:51], s11 offen offset:3072
    s_add_u32 s11, s10, 12288
    buffer_load_dwordx4 a[240:243], v6, s[48:51], s11 offen offset:0
    buffer_load_dwordx4 a[244:247], v6, s[48:51], s11 offen offset:1024
    buffer_load_dwordx4 a[248:251], v6, s[48:51], s11 offen offset:2048
    buffer_load_dwordx4 a[252:255], v6, s[48:51], s11 offen offset:3072
    s_add_u32 s9, s8, 4
    s_lshr_b32 s10, s9, 3
    s_lshl_b32 s10, s10, 8
    s_and_b32 s11, s9, 7
    s_add_u32 s10, s10, s11
    s_lshl_b32 s11, s5, 3
    s_add_u32 s10, s10, s11
    s_lshl_b32 s10, s10, 14
    s_add_u32 s10, s10, 4194304
    s_add_u32 s11, s10, 0
    buffer_load_dwordx4 v[128:131], v6, s[48:51], s11 offen offset:0
    buffer_load_dwordx4 v[132:135], v6, s[48:51], s11 offen offset:1024
    buffer_load_dwordx4 v[136:139], v6, s[48:51], s11 offen offset:2048
    buffer_load_dwordx4 v[140:143], v6, s[48:51], s11 offen offset:3072
    s_add_u32 s11, s10, 4096
    buffer_load_dwordx4 v[144:147], v6, s[48:51], s11 offen offset:0
    buffer_load_dwordx4 v[148:151], v6, s[48:51], s11 offen offset:1024
    buffer_load_dwordx4 v[152:155], v6, s[48:51], s11 offen offset:2048
    buffer_load_dwordx4 v[156:159], v6, s[48:51], s11 offen offset:3072
    s_add_u32 s11, s10, 8192
    buffer_load_dwordx4 v[160:163], v6, s[48:51], s11 offen offset:0
    buffer_load_dwordx4 v[164:167], v6, s[48:51], s11 offen offset:1024
    buffer_load_dwordx4 v[168:171], v6, s[48:51], s11 offen offset:2048
    buffer_load_dwordx4 v[172:175], v6, s[48:51], s11 offen offset:3072
    s_add_u32 s11, s10, 12288
    buffer_load_dwordx4 v[176:179], v6, s[48:51], s11 offen offset:0
    buffer_load_dwordx4 v[180:183], v6, s[48:51], s11 offen offset:1024
    buffer_load_dwordx4 v[184:187], v6, s[48:51], s11 offen offset:2048
    buffer_load_dwordx4 v[188:191], v6, s[48:51], s11 offen offset:3072
    s_add_u32 s9, s8, 5
    s_lshr_b32 s10, s9, 3
    s_lshl_b32 s10, s10, 8
    s_and_b32 s11, s9, 7
    s_add_u32 s10, s10, s11
    s_lshl_b32 s11, s5, 3
    s_add_u32 s10, s10, s11
    s_lshl_b32 s10, s10, 14
    s_add_u32 s10, s10, 4194304
    s_add_u32 s11, s10, 0
    buffer_load_dwordx4 v[192:195], v6, s[48:51], s11 offen offset:0
    buffer_load_dwordx4 v[196:199], v6, s[48:51], s11 offen offset:1024
    buffer_load_dwordx4 v[200:203], v6, s[48:51], s11 offen offset:2048
    buffer_load_dwordx4 v[204:207], v6, s[48:51], s11 offen offset:3072
    s_add_u32 s11, s10, 4096
    buffer_load_dwordx4 v[208:211], v6, s[48:51], s11 offen offset:0
    buffer_load_dwordx4 v[212:215], v6, s[48:51], s11 offen offset:1024
    buffer_load_dwordx4 v[216:219], v6, s[48:51], s11 offen offset:2048
    buffer_load_dwordx4 v[220:223], v6, s[48:51], s11 offen offset:3072
    s_add_u32 s11, s10, 8192
    buffer_load_dwordx4 v[224:227], v6, s[48:51], s11 offen offset:0
    buffer_load_dwordx4 v[228:231], v6, s[48:51], s11 offen offset:1024
    buffer_load_dwordx4 v[232:235], v6, s[48:51], s11 offen offset:2048
    buffer_load_dwordx4 v[236:239], v6, s[48:51], s11 offen offset:3072
    s_add_u32 s11, s10, 12288
    buffer_load_dwordx4 v[240:243], v6, s[48:51], s11 offen offset:0
    buffer_load_dwordx4 v[244:247], v6, s[48:51], s11 offen offset:1024
    buffer_load_dwordx4 v[248:251], v6, s[48:51], s11 offen offset:2048
    buffer_load_dwordx4 v[252:255], v6, s[48:51], s11 offen offset:3072
    s_lshl_b32 s10, s5, 17
    s_add_u32 s10, s10, 16777216
    v_lshlrev_b32 v7, 4, v0
    s_add_u32 s11, s10, 0
    buffer_load_dwordx4 v[64:67], v7, s[48:51], s11 offen
    s_add_u32 s11, s10, 4096
    buffer_load_dwordx4 v[68:71], v7, s[48:51], s11 offen
    s_add_u32 s11, s10, 8192
    buffer_load_dwordx4 v[72:75], v7, s[48:51], s11 offen
    s_add_u32 s11, s10, 12288
    buffer_load_dwordx4 v[76:79], v7, s[48:51], s11 offen
    s_add_u32 s11, s10, 16384
    buffer_load_dwordx4 v[80:83], v7, s[48:51], s11 offen
    s_add_u32 s11, s10, 20480
    buffer_load_dwordx4 v[84:87], v7, s[48:51], s11 offen
    s_add_u32 s11, s10, 24576
    buffer_load_dwordx4 v[88:91], v7, s[48:51], s11 offen
    s_add_u32 s11, s10, 28672
    buffer_load_dwordx4 v[92:95], v7, s[48:51], s11 offen
    s_waitcnt vmcnt(0)
    v_add_u32 v10, 20480, v7
    ds_write_b128 v10, v[64:67] offset:0
    ds_write_b128 v10, v[68:71] offset:4096
    ds_write_b128 v10, v[72:75] offset:8192
    ds_write_b128 v10, v[76:79] offset:12288
    ds_write_b128 v10, v[80:83] offset:16384
    ds_write_b128 v10, v[84:87] offset:20480
    ds_write_b128 v10, v[88:91] offset:24576
    ds_write_b128 v10, v[92:95] offset:28672
    s_add_u32 s11, s10, 32768
    buffer_load_dwordx4 v[64:67], v7, s[48:51], s11 offen
    s_add_u32 s11, s10, 36864
    buffer_load_dwordx4 v[68:71], v7, s[48:51], s11 offen
    s_add_u32 s11, s10, 40960
    buffer_load_dwordx4 v[72:75], v7, s[48:51], s11 offen
    s_add_u32 s11, s10, 45056
    buffer_load_dwordx4 v[76:79], v7, s[48:51], s11 offen
    s_add_u32 s11, s10, 49152
    buffer_load_dwordx4 v[80:83], v7, s[48:51], s11 offen
    s_add_u32 s11, s10, 53248
    buffer_load_dwordx4 v[84:87], v7, s[48:51], s11 offen
    s_add_u32 s11, s10, 57344
    buffer_load_dwordx4 v[88:91], v7, s[48:51], s11 offen
    s_add_u32 s11, s10, 61440
    buffer_load_dwordx4 v[92:95], v7, s[48:51], s11 offen
    s_waitcnt vmcnt(0)
    v_add_u32 v10, 53248, v7
    ds_write_b128 v10, v[64:67] offset:0
    ds_write_b128 v10, v[68:71] offset:4096
    ds_write_b128 v10, v[72:75] offset:8192
    ds_write_b128 v10, v[76:79] offset:12288
    ds_write_b128 v10, v[80:83] offset:16384
    ds_write_b128 v10, v[84:87] offset:20480
    ds_write_b128 v10, v[88:91] offset:24576
    ds_write_b128 v10, v[92:95] offset:28672
    s_add_u32 s11, s10, 65536
    buffer_load_dwordx4 v[64:67], v7, s[48:51], s11 offen
    s_add_u32 s11, s10, 69632
    buffer_load_dwordx4 v[68:71], v7, s[48:51], s11 offen
    s_add_u32 s11, s10, 73728
    buffer_load_dwordx4 v[72:75], v7, s[48:51], s11 offen
    s_add_u32 s11, s10, 77824
    buffer_load_dwordx4 v[76:79], v7, s[48:51], s11 offen
    s_add_u32 s11, s10, 81920
    buffer_load_dwordx4 v[80:83], v7, s[48:51], s11 offen
    s_add_u32 s11, s10, 86016
    buffer_load_dwordx4 v[84:87], v7, s[48:51], s11 offen
    s_add_u32 s11, s10, 90112
    buffer_load_dwordx4 v[88:91], v7, s[48:51], s11 offen
    s_add_u32 s11, s10, 94208
    buffer_load_dwordx4 v[92:95], v7, s[48:51], s11 offen
    s_waitcnt vmcnt(0)
    v_add_u32 v10, 86016, v7
    ds_write_b128 v10, v[64:67] offset:0
    ds_write_b128 v10, v[68:71] offset:4096
    ds_write_b128 v10, v[72:75] offset:8192
    ds_write_b128 v10, v[76:79] offset:12288
    ds_write_b128 v10, v[80:83] offset:16384
    ds_write_b128 v10, v[84:87] offset:20480
    ds_write_b128 v10, v[88:91] offset:24576
    ds_write_b128 v10, v[92:95] offset:28672
    s_add_u32 s11, s10, 98304
    buffer_load_dwordx4 v[64:67], v7, s[48:51], s11 offen
    s_add_u32 s11, s10, 102400
    buffer_load_dwordx4 v[68:71], v7, s[48:51], s11 offen
    s_add_u32 s11, s10, 106496
    buffer_load_dwordx4 v[72:75], v7, s[48:51], s11 offen
    s_add_u32 s11, s10, 110592
    buffer_load_dwordx4 v[76:79], v7, s[48:51], s11 offen
    s_add_u32 s11, s10, 114688
    buffer_load_dwordx4 v[80:83], v7, s[48:51], s11 offen
    s_add_u32 s11, s10, 118784
    buffer_load_dwordx4 v[84:87], v7, s[48:51], s11 offen
    s_add_u32 s11, s10, 122880
    buffer_load_dwordx4 v[88:91], v7, s[48:51], s11 offen
    s_add_u32 s11, s10, 126976
    buffer_load_dwordx4 v[92:95], v7, s[48:51], s11 offen
    s_waitcnt vmcnt(0)
    v_add_u32 v10, 118784, v7
    ds_write_b128 v10, v[64:67] offset:0
    ds_write_b128 v10, v[68:71] offset:4096
    ds_write_b128 v10, v[72:75] offset:8192
    ds_write_b128 v10, v[76:79] offset:12288
    ds_write_b128 v10, v[80:83] offset:16384
    ds_write_b128 v10, v[84:87] offset:20480
    ds_write_b128 v10, v[88:91] offset:24576
    ds_write_b128 v10, v[92:95] offset:28672
    v_lshrrev_b32 v8, 6, v0
    v_mul_u32_u24 v8, 2080, v8
    v_lshl_add_u32 v8, v2, 4, v8
    v_add_u32 v8, 0, v8
    v_lshlrev_b32 v9, 4, v2
    v_lshl_add_u32 v9, v1, 11, v9
    buffer_load_dwordx4 v[64:67], v9, s[52:55], 0 offen
    buffer_load_dwordx4 v[68:71], v9, s[52:55], 0 offen offset:1024
    s_waitcnt vmcnt(0)
    ds_write_b128 v8, v[64:67]
    ds_write_b128 v8, v[68:71] offset:1040
    s_mov_b32 s12, 0
    v_and_b32 v5, 7, v2
k3_loop_7:
    s_lshl_b32 s13, s12, 5
    v_add_u32 v8, s13, v4
    v_lshlrev_b32 v8, 13, v8
    v_lshl_add_u32 v8, v3, 4, v8
    s_lshl_b32 s14, s5, 8
    s_add_u32 s14, s14, 50331648
    s_add_u32 s15, s14, 0
    buffer_load_dwordx4 v[32:35], v8, s[48:51], s15 offen offset:0
    s_add_u32 s15, s14, 0
    buffer_load_dwordx4 v[36:39], v8, s[48:51], s15 offen offset:64
    s_add_u32 s15, s14, 0
    buffer_load_dwordx4 v[40:43], v8, s[48:51], s15 offen offset:128
    s_add_u32 s15, s14, 0
    buffer_load_dwordx4 v[44:47], v8, s[48:51], s15 offen offset:192
    s_add_u32 s15, s14, 131072
    buffer_load_dwordx4 v[48:51], v8, s[48:51], s15 offen offset:0
    s_add_u32 s15, s14, 131072
    buffer_load_dwordx4 v[52:55], v8, s[48:51], s15 offen offset:64
    s_add_u32 s15, s14, 131072
    buffer_load_dwordx4 v[56:59], v8, s[48:51], s15 offen offset:128
    s_add_u32 s15, s14, 131072
    buffer_load_dwordx4 v[60:63], v8, s[48:51], s15 offen offset:192
    s_lshl_b32 s15, s3, 5
    s_lshl_b32 s16, s5, 7
    s_add_u32 s15, s15, s16
    v_add_u32 v8, s15, v4
    v_lshlrev_b32 v8, 12, v8
    v_lshl_add_u32 v8, v3, 3, v8
    s_lshl_b32 s16, s12, 6
    s_add_u32 s16, s16, 67108864
    s_add_u32 s17, s16, 0
    buffer_load_dwordx2 v[16:17], v8, s[48:51], s17 offen
    buffer_load_dwordx2 v[18:19], v8, s[48:51], s17 offen offset:32
    s_add_u32 s17, s16, 65536
    buffer_load_dwordx2 v[20:21], v8, s[48:51], s17 offen
    buffer_load_dwordx2 v[22:23], v8, s[48:51], s17 offen offset:32
    s_waitcnt lgkmcnt(0)
    s_barrier
    v_mul_u32_u24 v8, 1040, v5
    v_lshl_add_u32 v8, v3, 4, v8
    v_add_u32 v8, 0, v8
    ds_read_b128 v[64:67], v8 offset:0
    ds_read_b128 v[68:71], v8 offset:64
    ds_read_b128 v[72:75], v8 offset:128
    ds_read_b128 v[76:79], v8 offset:192
    ds_read_b128 v[80:83], v8 offset:256
    ds_read_b128 v[84:87], v8 offset:320
    ds_read_b128 v[88:91], v8 offset:384
    ds_read_b128 v[92:95], v8 offset:448
    ds_read_b128 v[96:99], v8 offset:512
    ds_read_b128 v[100:103], v8 offset:576
    ds_read_b128 v[104:107], v8 offset:640
    ds_read_b128 v[108:111], v8 offset:704
    ds_read_b128 v[112:115], v8 offset:768
    ds_read_b128 v[116:119], v8 offset:832
    ds_read_b128 v[120:123], v8 offset:896
    ds_read_b128 v[124:127], v8 offset:960
    s_waitcnt lgkmcnt(0)
    s_cmp_lg_u32 s3, 0
    s_cbranch_scc1 qw_9
    v_mfma_f32_16x16x32_bf16 v[8:11], a[0:3], v[64:67], 0
    v_mfma_f32_16x16x32_bf16 v[12:15], a[64:67], v[64:67], 0
    v_mfma_f32_16x16x32_bf16 v[8:11], a[4:7], v[68:71], v[8:11]
    v_mfma_f32_16x16x32_bf16 v[12:15], a[68:71], v[68:71], v[12:15]
    v_mfma_f32_16x16x32_bf16 v[8:11], a[8:11], v[72:75], v[8:11]
    v_mfma_f32_16x16x32_bf16 v[12:15], a[72:75], v[72:75], v[12:15]
    v_mfma_f32_16x16x32_bf16 v[8:11], a[12:15], v[76:79], v[8:11]
    v_mfma_f32_16x16x32_bf16 v[12:15], a[76:79], v[76:79], v[12:15]
    v_mfma_f32_16x16x32_bf16 v[8:11], a[16:19], v[80:83], v[8:11]
    v_mfma_f32_16x16x32_bf16 v[12:15], a[80:83], v[80:83], v[12:15]
    v_mfma_f32_16x16x32_bf16 v[8:11], a[20:23], v[84:87], v[8:11]
    v_mfma_f32_16x16x32_bf16 v[12:15], a[84:87], v[84:87], v[12:15]
    v_mfma_f32_16x16x32_bf16 v[8:11], a[24:27], v[88:91], v[8:11]
    v_mfma_f32_16x16x32_bf16 v[12:15], a[88:91], v[88:91], v[12:15]
    v_mfma_f32_16x16x32_bf16 v[8:11], a[28:31], v[92:95], v[8:11]
    v_mfma_f32_16x16x32_bf16 v[12:15], a[92:95], v[92:95], v[12:15]
    v_mfma_f32_16x16x32_bf16 v[8:11], a[32:35], v[96:99], v[8:11]
    v_mfma_f32_16x16x32_bf16 v[12:15], a[96:99], v[96:99], v[12:15]
    v_mfma_f32_16x16x32_bf16 v[8:11], a[36:39], v[100:103], v[8:11]
    v_mfma_f32_16x16x32_bf16 v[12:15], a[100:103], v[100:103], v[12:15]
    v_mfma_f32_16x16x32_bf16 v[8:11], a[40:43], v[104:107], v[8:11]
    v_mfma_f32_16x16x32_bf16 v[12:15], a[104:107], v[104:107], v[12:15]
    v_mfma_f32_16x16x32_bf16 v[8:11], a[44:47], v[108:111], v[8:11]
    v_mfma_f32_16x16x32_bf16 v[12:15], a[108:111], v[108:111], v[12:15]
    v_mfma_f32_16x16x32_bf16 v[8:11], a[48:51], v[112:115], v[8:11]
    v_mfma_f32_16x16x32_bf16 v[12:15], a[112:115], v[112:115], v[12:15]
    v_mfma_f32_16x16x32_bf16 v[8:11], a[52:55], v[116:119], v[8:11]
    v_mfma_f32_16x16x32_bf16 v[12:15], a[116:119], v[116:119], v[12:15]
    v_mfma_f32_16x16x32_bf16 v[8:11], a[56:59], v[120:123], v[8:11]
    v_mfma_f32_16x16x32_bf16 v[12:15], a[120:123], v[120:123], v[12:15]
    v_mfma_f32_16x16x32_bf16 v[8:11], a[60:63], v[124:127], v[8:11]
    v_mfma_f32_16x16x32_bf16 v[12:15], a[124:127], v[124:127], v[12:15]
    s_nop 7
    v_cvt_pk_bf16_f32 v6, v8, v9
    v_cvt_pk_bf16_f32 v7, v10, v11
    v_mul_u32_u24 v1, 528, v4
    v_lshl_add_u32 v1, v3, 3, v1
    v_cmp_gt_u32 vcc, 8, v4
    s_and_saveexec_b64 s[20:21], vcc
    ds_write_b64 v1, v[6:7] offset:8320
    s_mov_b64 exec, -1
    s_nop 1
    v_cvt_pk_bf16_f32 v6, v12, v13
    v_cvt_pk_bf16_f32 v7, v14, v15
    v_mul_u32_u24 v1, 528, v4
    v_lshl_add_u32 v1, v3, 3, v1
    v_cmp_gt_u32 vcc, 8, v4
    s_and_saveexec_b64 s[20:21], vcc
    ds_write_b64 v1, v[6:7] offset:8352
    s_mov_b64 exec, -1
    s_nop 1
    v_mfma_f32_16x16x32_bf16 v[8:11], a[128:131], v[64:67], 0
    v_mfma_f32_16x16x32_bf16 v[12:15], a[192:195], v[64:67], 0
    v_mfma_f32_16x16x32_bf16 v[8:11], a[132:135], v[68:71], v[8:11]
    v_mfma_f32_16x16x32_bf16 v[12:15], a[196:199], v[68:71], v[12:15]
    v_mfma_f32_16x16x32_bf16 v[8:11], a[136:139], v[72:75], v[8:11]
    v_mfma_f32_16x16x32_bf16 v[12:15], a[200:203], v[72:75], v[12:15]
    v_mfma_f32_16x16x32_bf16 v[8:11], a[140:143], v[76:79], v[8:11]
    v_mfma_f32_16x16x32_bf16 v[12:15], a[204:207], v[76:79], v[12:15]
    v_mfma_f32_16x16x32_bf16 v[8:11], a[144:147], v[80:83], v[8:11]
    v_mfma_f32_16x16x32_bf16 v[12:15], a[208:211], v[80:83], v[12:15]
    v_mfma_f32_16x16x32_bf16 v[8:11], a[148:151], v[84:87], v[8:11]
    v_mfma_f32_16x16x32_bf16 v[12:15], a[212:215], v[84:87], v[12:15]
    v_mfma_f32_16x16x32_bf16 v[8:11], a[152:155], v[88:91], v[8:11]
    v_mfma_f32_16x16x32_bf16 v[12:15], a[216:219], v[88:91], v[12:15]
    v_mfma_f32_16x16x32_bf16 v[8:11], a[156:159], v[92:95], v[8:11]
    v_mfma_f32_16x16x32_bf16 v[12:15], a[220:223], v[92:95], v[12:15]
    v_mfma_f32_16x16x32_bf16 v[8:11], a[160:163], v[96:99], v[8:11]
    v_mfma_f32_16x16x32_bf16 v[12:15], a[224:227], v[96:99], v[12:15]
    v_mfma_f32_16x16x32_bf16 v[8:11], a[164:167], v[100:103], v[8:11]
    v_mfma_f32_16x16x32_bf16 v[12:15], a[228:231], v[100:103], v[12:15]
    v_mfma_f32_16x16x32_bf16 v[8:11], a[168:171], v[104:107], v[8:11]
    v_mfma_f32_16x16x32_bf16 v[12:15], a[232:235], v[104:107], v[12:15]
    v_mfma_f32_16x16x32_bf16 v[8:11], a[172:175], v[108:111], v[8:11]
    v_mfma_f32_16x16x32_bf16 v[12:15], a[236:239], v[108:111], v[12:15]
    v_mfma_f32_16x16x32_bf16 v[8:11], a[176:179], v[112:115], v[8:11]
    v_mfma_f32_16x16x32_bf16 v[12:15], a[240:243], v[112:115], v[12:15]
    v_mfma_f32_16x16x32_bf16 v[8:11], a[180:183], v[116:119], v[8:11]
    v_mfma_f32_16x16x32_bf16 v[12:15], a[244:247], v[116:119], v[12:15]
    v_mfma_f32_16x16x32_bf16 v[8:11], a[184:187], v[120:123], v[8:11]
    v_mfma_f32_16x16x32_bf16 v[12:15], a[248:251], v[120:123], v[12:15]
    v_mfma_f32_16x16x32_bf16 v[8:11], a[188:191], v[124:127], v[8:11]
    v_mfma_f32_16x16x32_bf16 v[12:15], a[252:255], v[124:127], v[12:15]
    s_nop 7
    v_cvt_pk_bf16_f32 v6, v8, v9
    v_cvt_pk_bf16_f32 v7, v10, v11
    v_mul_u32_u24 v1, 528, v4
    v_lshl_add_u32 v1, v3, 3, v1
    v_cmp_gt_u32 vcc, 8, v4
    s_and_saveexec_b64 s[20:21], vcc
    ds_write_b64 v1, v[6:7] offset:8384
    s_mov_b64 exec, -1
    s_nop 1
    v_cvt_pk_bf16_f32 v6, v12, v13
    v_cvt_pk_bf16_f32 v7, v14, v15
    v_mul_u32_u24 v1, 528, v4
    v_lshl_add_u32 v1, v3, 3, v1
    v_cmp_gt_u32 vcc, 8, v4
    s_and_saveexec_b64 s[20:21], vcc
    ds_write_b64 v1, v[6:7] offset:8416
    s_mov_b64 exec, -1
    s_nop 1
    v_mfma_f32_16x16x32_bf16 v[8:11], v[128:131], v[64:67], 0
    v_mfma_f32_16x16x32_bf16 v[12:15], v[192:195], v[64:67], 0
    v_mfma_f32_16x16x32_bf16 v[8:11], v[132:135], v[68:71], v[8:11]
    v_mfma_f32_16x16x32_bf16 v[12:15], v[196:199], v[68:71], v[12:15]
    v_mfma_f32_16x16x32_bf16 v[8:11], v[136:139], v[72:75], v[8:11]
    v_mfma_f32_16x16x32_bf16 v[12:15], v[200:203], v[72:75], v[12:15]
    v_mfma_f32_16x16x32_bf16 v[8:11], v[140:143], v[76:79], v[8:11]
    v_mfma_f32_16x16x32_bf16 v[12:15], v[204:207], v[76:79], v[12:15]
    v_mfma_f32_16x16x32_bf16 v[8:11], v[144:147], v[80:83], v[8:11]
    v_mfma_f32_16x16x32_bf16 v[12:15], v[208:211], v[80:83], v[12:15]
    v_mfma_f32_16x16x32_bf16 v[8:11], v[148:151], v[84:87], v[8:11]
    v_mfma_f32_16x16x32_bf16 v[12:15], v[212:215], v[84:87], v[12:15]
    v_mfma_f32_16x16x32_bf16 v[8:11], v[152:155], v[88:91], v[8:11]
    v_mfma_f32_16x16x32_bf16 v[12:15], v[216:219], v[88:91], v[12:15]
    v_mfma_f32_16x16x32_bf16 v[8:11], v[156:159], v[92:95], v[8:11]
    v_mfma_f32_16x16x32_bf16 v[12:15], v[220:223], v[92:95], v[12:15]
    v_mfma_f32_16x16x32_bf16 v[8:11], v[160:163], v[96:99], v[8:11]
    v_mfma_f32_16x16x32_bf16 v[12:15], v[224:227], v[96:99], v[12:15]
    v_mfma_f32_16x16x32_bf16 v[8:11], v[164:167], v[100:103], v[8:11]
    v_mfma_f32_16x16x32_bf16 v[12:15], v[228:231], v[100:103], v[12:15]
    v_mfma_f32_16x16x32_bf16 v[8:11], v[168:171], v[104:107], v[8:11]
    v_mfma_f32_16x16x32_bf16 v[12:15], v[232:235], v[104:107], v[12:15]
    v_mfma_f32_16x16x32_bf16 v[8:11], v[172:175], v[108:111], v[8:11]
    v_mfma_f32_16x16x32_bf16 v[12:15], v[236:239], v[108:111], v[12:15]
    v_mfma_f32_16x16x32_bf16 v[8:11], v[176:179], v[112:115], v[8:11]
    v_mfma_f32_16x16x32_bf16 v[12:15], v[240:243], v[112:115], v[12:15]
    v_mfma_f32_16x16x32_bf16 v[8:11], v[180:183], v[116:119], v[8:11]
    v_mfma_f32_16x16x32_bf16 v[12:15], v[244:247], v[116:119], v[12:15]
    v_mfma_f32_16x16x32_bf16 v[8:11], v[184:187], v[120:123], v[8:11]
    v_mfma_f32_16x16x32_bf16 v[12:15], v[248:251], v[120:123], v[12:15]
    v_mfma_f32_16x16x32_bf16 v[8:11], v[188:191], v[124:127], v[8:11]
    v_mfma_f32_16x16x32_bf16 v[12:15], v[252:255], v[124:127], v[12:15]
    s_nop 7
    v_cvt_pk_bf16_f32 v6, v8, v9
    v_cvt_pk_bf16_f32 v7, v10, v11
    v_mul_u32_u24 v1, 528, v4
    v_lshl_add_u32 v1, v3, 3, v1
    v_cmp_gt_u32 vcc, 8, v4
    s_and_saveexec_b64 s[20:21], vcc
    ds_write_b64 v1, v[6:7] offset:8448
    s_mov_b64 exec, -1
    s_nop 1
    v_cvt_pk_bf16_f32 v6, v12, v13
    v_cvt_pk_bf16_f32 v7, v14, v15
    v_mul_u32_u24 v1, 528, v4
    v_lshl_add_u32 v1, v3, 3, v1
    v_cmp_gt_u32 vcc, 8, v4
    s_and_saveexec_b64 s[20:21], vcc
    ds_write_b64 v1, v[6:7] offset:8480
    s_mov_b64 exec, -1
    s_nop 1
    s_branch qe_8
qw_9:
    s_cmp_lg_u32 s3, 1
    s_cbranch_scc1 qw_10
    v_mfma_f32_16x16x32_bf16 v[8:11], a[0:3], v[64:67], 0
    v_mfma_f32_16x16x32_bf16 v[12:15], a[64:67], v[64:67], 0
    v_mfma_f32_16x16x32_bf16 v[8:11], a[4:7], v[68:71], v[8:11]
    v_mfma_f32_16x16x32_bf16 v[12:15], a[68:71], v[68:71], v[12:15]
    v_mfma_f32_16x16x32_bf16 v[8:11], a[8:11], v[72:75], v[8:11]
    v_mfma_f32_16x16x32_bf16 v[12:15], a[72:75], v[72:75], v[12:15]
    v_mfma_f32_16x16x32_bf16 v[8:11], a[12:15], v[76:79], v[8:11]
    v_mfma_f32_16x16x32_bf16 v[12:15], a[76:79], v[76:79], v[12:15]
    v_mfma_f32_16x16x32_bf16 v[8:11], a[16:19], v[80:83], v[8:11]
    v_mfma_f32_16x16x32_bf16 v[12:15], a[80:83], v[80:83], v[12:15]
    v_mfma_f32_16x16x32_bf16 v[8:11], a[20:23], v[84:87], v[8:11]
    v_mfma_f32_16x16x32_bf16 v[12:15], a[84:87], v[84:87], v[12:15]
    v_mfma_f32_16x16x32_bf16 v[8:11], a[24:27], v[88:91], v[8:11]
    v_mfma_f32_16x16x32_bf16 v[12:15], a[88:91], v[88:91], v[12:15]
    v_mfma_f32_16x16x32_bf16 v[8:11], a[28:31], v[92:95], v[8:11]
    v_mfma_f32_16x16x32_bf16 v[12:15], a[92:95], v[92:95], v[12:15]
    v_mfma_f32_16x16x32_bf16 v[8:11], a[32:35], v[96:99], v[8:11]
    v_mfma_f32_16x16x32_bf16 v[12:15], a[96:99], v[96:99], v[12:15]
    v_mfma_f32_16x16x32_bf16 v[8:11], a[36:39], v[100:103], v[8:11]
    v_mfma_f32_16x16x32_bf16 v[12:15], a[100:103], v[100:103], v[12:15]
    v_mfma_f32_16x16x32_bf16 v[8:11], a[40:43], v[104:107], v[8:11]
    v_mfma_f32_16x16x32_bf16 v[12:15], a[104:107], v[104:107], v[12:15]
    v_mfma_f32_16x16x32_bf16 v[8:11], a[44:47], v[108:111], v[8:11]
    v_mfma_f32_16x16x32_bf16 v[12:15], a[108:111], v[108:111], v[12:15]
    v_mfma_f32_16x16x32_bf16 v[8:11], a[48:51], v[112:115], v[8:11]
    v_mfma_f32_16x16x32_bf16 v[12:15], a[112:115], v[112:115], v[12:15]
    v_mfma_f32_16x16x32_bf16 v[8:11], a[52:55], v[116:119], v[8:11]
    v_mfma_f32_16x16x32_bf16 v[12:15], a[116:119], v[116:119], v[12:15]
    v_mfma_f32_16x16x32_bf16 v[8:11], a[56:59], v[120:123], v[8:11]
    v_mfma_f32_16x16x32_bf16 v[12:15], a[120:123], v[120:123], v[12:15]
    v_mfma_f32_16x16x32_bf16 v[8:11], a[60:63], v[124:127], v[8:11]
    v_mfma_f32_16x16x32_bf16 v[12:15], a[124:127], v[124:127], v[12:15]
    s_nop 7
    v_cvt_pk_bf16_f32 v6, v8, v9
    v_cvt_pk_bf16_f32 v7, v10, v11
    v_mul_u32_u24 v1, 528, v4
    v_lshl_add_u32 v1, v3, 3, v1
    v_cmp_gt_u32 vcc, 8, v4
    s_and_saveexec_b64 s[20:21], vcc
    ds_write_b64 v1, v[6:7] offset:8512
    s_mov_b64 exec, -1
    s_nop 1
    v_cvt_pk_bf16_f32 v6, v12, v13
    v_cvt_pk_bf16_f32 v7, v14, v15
    v_mul_u32_u24 v1, 528, v4
    v_lshl_add_u32 v1, v3, 3, v1
    v_cmp_gt_u32 vcc, 8, v4
    s_and_saveexec_b64 s[20:21], vcc
    ds_write_b64 v1, v[6:7] offset:8544
    s_mov_b64 exec, -1
    s_nop 1
    v_mfma_f32_16x16x32_bf16 v[8:11], a[128:131], v[64:67], 0
    v_mfma_f32_16x16x32_bf16 v[12:15], a[192:195], v[64:67], 0
    v_mfma_f32_16x16x32_bf16 v[8:11], a[132:135], v[68:71], v[8:11]
    v_mfma_f32_16x16x32_bf16 v[12:15], a[196:199], v[68:71], v[12:15]
    v_mfma_f32_16x16x32_bf16 v[8:11], a[136:139], v[72:75], v[8:11]
    v_mfma_f32_16x16x32_bf16 v[12:15], a[200:203], v[72:75], v[12:15]
    v_mfma_f32_16x16x32_bf16 v[8:11], a[140:143], v[76:79], v[8:11]
    v_mfma_f32_16x16x32_bf16 v[12:15], a[204:207], v[76:79], v[12:15]
    v_mfma_f32_16x16x32_bf16 v[8:11], a[144:147], v[80:83], v[8:11]
    v_mfma_f32_16x16x32_bf16 v[12:15], a[208:211], v[80:83], v[12:15]
    v_mfma_f32_16x16x32_bf16 v[8:11], a[148:151], v[84:87], v[8:11]
    v_mfma_f32_16x16x32_bf16 v[12:15], a[212:215], v[84:87], v[12:15]
    v_mfma_f32_16x16x32_bf16 v[8:11], a[152:155], v[88:91], v[8:11]
    v_mfma_f32_16x16x32_bf16 v[12:15], a[216:219], v[88:91], v[12:15]
    v_mfma_f32_16x16x32_bf16 v[8:11], a[156:159], v[92:95], v[8:11]
    v_mfma_f32_16x16x32_bf16 v[12:15], a[220:223], v[92:95], v[12:15]
    v_mfma_f32_16x16x32_bf16 v[8:11], a[160:163], v[96:99], v[8:11]
    v_mfma_f32_16x16x32_bf16 v[12:15], a[224:227], v[96:99], v[12:15]
    v_mfma_f32_16x16x32_bf16 v[8:11], a[164:167], v[100:103], v[8:11]
    v_mfma_f32_16x16x32_bf16 v[12:15], a[228:231], v[100:103], v[12:15]
    v_mfma_f32_16x16x32_bf16 v[8:11], a[168:171], v[104:107], v[8:11]
    v_mfma_f32_16x16x32_bf16 v[12:15], a[232:235], v[104:107], v[12:15]
    v_mfma_f32_16x16x32_bf16 v[8:11], a[172:175], v[108:111], v[8:11]
    v_mfma_f32_16x16x32_bf16 v[12:15], a[236:239], v[108:111], v[12:15]
    v_mfma_f32_16x16x32_bf16 v[8:11], a[176:179], v[112:115], v[8:11]
    v_mfma_f32_16x16x32_bf16 v[12:15], a[240:243], v[112:115], v[12:15]
    v_mfma_f32_16x16x32_bf16 v[8:11], a[180:183], v[116:119], v[8:11]
    v_mfma_f32_16x16x32_bf16 v[12:15], a[244:247], v[116:119], v[12:15]
    v_mfma_f32_16x16x32_bf16 v[8:11], a[184:187], v[120:123], v[8:11]
    v_mfma_f32_16x16x32_bf16 v[12:15], a[248:251], v[120:123], v[12:15]
    v_mfma_f32_16x16x32_bf16 v[8:11], a[188:191], v[124:127], v[8:11]
    v_mfma_f32_16x16x32_bf16 v[12:15], a[252:255], v[124:127], v[12:15]
    s_nop 7
    v_cvt_pk_bf16_f32 v6, v8, v9
    v_cvt_pk_bf16_f32 v7, v10, v11
    v_mul_u32_u24 v1, 528, v4
    v_lshl_add_u32 v1, v3, 3, v1
    v_cmp_gt_u32 vcc, 8, v4
    s_and_saveexec_b64 s[20:21], vcc
    ds_write_b64 v1, v[6:7] offset:8576
    v_lshlrev_b32 v1, 13, v4
    v_lshl_add_u32 v1, v3, 3, v1
    s_lshl_b32 s22, s12, 16
    s_lshl_b32 s23, s5, 8
    s_add_u32 s22, s22, s23
    s_add_u32 s22, s22, 83886080
    buffer_store_dwordx2 v[6:7], v1, s[48:51], s22 offen
    s_mov_b64 exec, -1
    s_nop 1
    v_cvt_pk_bf16_f32 v6, v12, v13
    v_cvt_pk_bf16_f32 v7, v14, v15
    v_mul_u32_u24 v1, 528, v4
    v_lshl_add_u32 v1, v3, 3, v1
    v_cmp_gt_u32 vcc, 8, v4
    s_and_saveexec_b64 s[20:21], vcc
    ds_write_b64 v1, v[6:7] offset:8608
    v_lshlrev_b32 v1, 13, v4
    v_lshl_add_u32 v1, v3, 3, v1
    s_lshl_b32 s22, s12, 16
    s_lshl_b32 s23, s5, 8
    s_add_u32 s22, s22, s23
    s_add_u32 s22, s22, 83886112
    buffer_store_dwordx2 v[6:7], v1, s[48:51], s22 offen
    s_mov_b64 exec, -1
    s_nop 1
    v_mfma_f32_16x16x32_bf16 v[8:11], v[128:131], v[64:67], 0
    v_mfma_f32_16x16x32_bf16 v[12:15], v[192:195], v[64:67], 0
    v_mfma_f32_16x16x32_bf16 v[8:11], v[132:135], v[68:71], v[8:11]
    v_mfma_f32_16x16x32_bf16 v[12:15], v[196:199], v[68:71], v[12:15]
    v_mfma_f32_16x16x32_bf16 v[8:11], v[136:139], v[72:75], v[8:11]
    v_mfma_f32_16x16x32_bf16 v[12:15], v[200:203], v[72:75], v[12:15]
    v_mfma_f32_16x16x32_bf16 v[8:11], v[140:143], v[76:79], v[8:11]
    v_mfma_f32_16x16x32_bf16 v[12:15], v[204:207], v[76:79], v[12:15]
    v_mfma_f32_16x16x32_bf16 v[8:11], v[144:147], v[80:83], v[8:11]
    v_mfma_f32_16x16x32_bf16 v[12:15], v[208:211], v[80:83], v[12:15]
    v_mfma_f32_16x16x32_bf16 v[8:11], v[148:151], v[84:87], v[8:11]
    v_mfma_f32_16x16x32_bf16 v[12:15], v[212:215], v[84:87], v[12:15]
    v_mfma_f32_16x16x32_bf16 v[8:11], v[152:155], v[88:91], v[8:11]
    v_mfma_f32_16x16x32_bf16 v[12:15], v[216:219], v[88:91], v[12:15]
    v_mfma_f32_16x16x32_bf16 v[8:11], v[156:159], v[92:95], v[8:11]
    v_mfma_f32_16x16x32_bf16 v[12:15], v[220:223], v[92:95], v[12:15]
    v_mfma_f32_16x16x32_bf16 v[8:11], v[160:163], v[96:99], v[8:11]
    v_mfma_f32_16x16x32_bf16 v[12:15], v[224:227], v[96:99], v[12:15]
    v_mfma_f32_16x16x32_bf16 v[8:11], v[164:167], v[100:103], v[8:11]
    v_mfma_f32_16x16x32_bf16 v[12:15], v[228:231], v[100:103], v[12:15]
    v_mfma_f32_16x16x32_bf16 v[8:11], v[168:171], v[104:107], v[8:11]
    v_mfma_f32_16x16x32_bf16 v[12:15], v[232:235], v[104:107], v[12:15]
    v_mfma_f32_16x16x32_bf16 v[8:11], v[172:175], v[108:111], v[8:11]
    v_mfma_f32_16x16x32_bf16 v[12:15], v[236:239], v[108:111], v[12:15]
    v_mfma_f32_16x16x32_bf16 v[8:11], v[176:179], v[112:115], v[8:11]
    v_mfma_f32_16x16x32_bf16 v[12:15], v[240:243], v[112:115], v[12:15]
    v_mfma_f32_16x16x32_bf16 v[8:11], v[180:183], v[116:119], v[8:11]
    v_mfma_f32_16x16x32_bf16 v[12:15], v[244:247], v[116:119], v[12:15]
    v_mfma_f32_16x16x32_bf16 v[8:11], v[184:187], v[120:123], v[8:11]
    v_mfma_f32_16x16x32_bf16 v[12:15], v[248:251], v[120:123], v[12:15]
    v_mfma_f32_16x16x32_bf16 v[8:11], v[188:191], v[124:127], v[8:11]
    v_mfma_f32_16x16x32_bf16 v[12:15], v[252:255], v[124:127], v[12:15]
    s_nop 7
    v_cvt_pk_bf16_f32 v6, v8, v9
    v_cvt_pk_bf16_f32 v7, v10, v11
    v_mul_u32_u24 v1, 528, v4
    v_lshl_add_u32 v1, v3, 3, v1
    v_cmp_gt_u32 vcc, 8, v4
    s_and_saveexec_b64 s[20:21], vcc
    ds_write_b64 v1, v[6:7] offset:8640
    v_lshlrev_b32 v1, 13, v4
    v_lshl_add_u32 v1, v3, 3, v1
    s_lshl_b32 s22, s12, 16
    s_lshl_b32 s23, s5, 8
    s_add_u32 s22, s22, s23
    s_add_u32 s22, s22, 83886144
    buffer_store_dwordx2 v[6:7], v1, s[48:51], s22 offen
    s_mov_b64 exec, -1
    s_nop 1
    v_cvt_pk_bf16_f32 v6, v12, v13
    v_cvt_pk_bf16_f32 v7, v14, v15
    v_mul_u32_u24 v1, 528, v4
    v_lshl_add_u32 v1, v3, 3, v1
    v_cmp_gt_u32 vcc, 8, v4
    s_and_saveexec_b64 s[20:21], vcc
    ds_write_b64 v1, v[6:7] offset:8672
    v_lshlrev_b32 v1, 13, v4
    v_lshl_add_u32 v1, v3, 3, v1
    s_lshl_b32 s22, s12, 16
    s_lshl_b32 s23, s5, 8
    s_add_u32 s22, s22, s23
    s_add_u32 s22, s22, 83886176
    buffer_store_dwordx2 v[6:7], v1, s[48:51], s22 offen
    s_mov_b64 exec, -1
    s_nop 1
    s_branch qe_8
qw_10:
    s_cmp_lg_u32 s3, 2
    s_cbranch_scc1 qw_11
    v_mfma_f32_16x16x32_bf16 v[8:11], a[0:3], v[64:67], 0
    v_mfma_f32_16x16x32_bf16 v[12:15], a[64:67], v[64:67], 0
    v_mfma_f32_16x16x32_bf16 v[8:11], a[4:7], v[68:71], v[8:11]
    v_mfma_f32_16x16x32_bf16 v[12:15], a[68:71], v[68:71], v[12:15]
    v_mfma_f32_16x16x32_bf16 v[8:11], a[8:11], v[72:75], v[8:11]
    v_mfma_f32_16x16x32_bf16 v[12:15], a[72:75], v[72:75], v[12:15]
    v_mfma_f32_16x16x32_bf16 v[8:11], a[12:15], v[76:79], v[8:11]
    v_mfma_f32_16x16x32_bf16 v[12:15], a[76:79], v[76:79], v[12:15]
    v_mfma_f32_16x16x32_bf16 v[8:11], a[16:19], v[80:83], v[8:11]
    v_mfma_f32_16x16x32_bf16 v[12:15], a[80:83], v[80:83], v[12:15]
    v_mfma_f32_16x16x32_bf16 v[8:11], a[20:23], v[84:87], v[8:11]
    v_mfma_f32_16x16x32_bf16 v[12:15], a[84:87], v[84:87], v[12:15]
    v_mfma_f32_16x16x32_bf16 v[8:11], a[24:27], v[88:91], v[8:11]
    v_mfma_f32_16x16x32_bf16 v[12:15], a[88:91], v[88:91], v[12:15]
    v_mfma_f32_16x16x32_bf16 v[8:11], a[28:31], v[92:95], v[8:11]
    v_mfma_f32_16x16x32_bf16 v[12:15], a[92:95], v[92:95], v[12:15]
    v_mfma_f32_16x16x32_bf16 v[8:11], a[32:35], v[96:99], v[8:11]
    v_mfma_f32_16x16x32_bf16 v[12:15], a[96:99], v[96:99], v[12:15]
    v_mfma_f32_16x16x32_bf16 v[8:11], a[36:39], v[100:103], v[8:11]
    v_mfma_f32_16x16x32_bf16 v[12:15], a[100:103], v[100:103], v[12:15]
    v_mfma_f32_16x16x32_bf16 v[8:11], a[40:43], v[104:107], v[8:11]
    v_mfma_f32_16x16x32_bf16 v[12:15], a[104:107], v[104:107], v[12:15]
    v_mfma_f32_16x16x32_bf16 v[8:11], a[44:47], v[108:111], v[8:11]
    v_mfma_f32_16x16x32_bf16 v[12:15], a[108:111], v[108:111], v[12:15]
    v_mfma_f32_16x16x32_bf16 v[8:11], a[48:51], v[112:115], v[8:11]
    v_mfma_f32_16x16x32_bf16 v[12:15], a[112:115], v[112:115], v[12:15]
    v_mfma_f32_16x16x32_bf16 v[8:11], a[52:55], v[116:119], v[8:11]
    v_mfma_f32_16x16x32_bf16 v[12:15], a[116:119], v[116:119], v[12:15]
    v_mfma_f32_16x16x32_bf16 v[8:11], a[56:59], v[120:123], v[8:11]
    v_mfma_f32_16x16x32_bf16 v[12:15], a[120:123], v[120:123], v[12:15]
    v_mfma_f32_16x16x32_bf16 v[8:11], a[60:63], v[124:127], v[8:11]
    v_mfma_f32_16x16x32_bf16 v[12:15], a[124:127], v[124:127], v[12:15]
    s_nop 7
    v_cvt_pk_bf16_f32 v6, v8, v9
    v_cvt_pk_bf16_f32 v7, v10, v11
    v_mul_u32_u24 v1, 528, v4
    v_lshl_add_u32 v1, v3, 3, v1
    v_cmp_gt_u32 vcc, 8, v4
    s_and_saveexec_b64 s[20:21], vcc
    ds_write_b64 v1, v[6:7] offset:8704
    v_lshlrev_b32 v1, 13, v4
    v_lshl_add_u32 v1, v3, 3, v1
    s_lshl_b32 s22, s12, 16
    s_lshl_b32 s23, s5, 8
    s_add_u32 s22, s22, s23
    s_add_u32 s22, s22, 83886208
    buffer_store_dwordx2 v[6:7], v1, s[48:51], s22 offen
    s_mov_b64 exec, -1
    s_nop 1
    v_cvt_pk_bf16_f32 v6, v12, v13
    v_cvt_pk_bf16_f32 v7, v14, v15
    v_mul_u32_u24 v1, 528, v4
    v_lshl_add_u32 v1, v3, 3, v1
    v_cmp_gt_u32 vcc, 8, v4
    s_and_saveexec_b64 s[20:21], vcc
    ds_write_b64 v1, v[6:7] offset:8736
    v_lshlrev_b32 v1, 13, v4
    v_lshl_add_u32 v1, v3, 3, v1
    s_lshl_b32 s22, s12, 16
    s_lshl_b32 s23, s5, 8
    s_add_u32 s22, s22, s23
    s_add_u32 s22, s22, 83886240
    buffer_store_dwordx2 v[6:7], v1, s[48:51], s22 offen
    s_mov_b64 exec, -1
    s_nop 1
    v_mfma_f32_16x16x32_bf16 v[8:11], a[128:131], v[64:67], 0
    v_mfma_f32_16x16x32_bf16 v[12:15], a[192:195], v[64:67], 0
    v_mfma_f32_16x16x32_bf16 v[8:11], a[132:135], v[68:71], v[8:11]
    v_mfma_f32_16x16x32_bf16 v[12:15], a[196:199], v[68:71], v[12:15]
    v_mfma_f32_16x16x32_bf16 v[8:11], a[136:139], v[72:75], v[8:11]
    v_mfma_f32_16x16x32_bf16 v[12:15], a[200:203], v[72:75], v[12:15]
    v_mfma_f32_16x16x32_bf16 v[8:11], a[140:143], v[76:79], v[8:11]
    v_mfma_f32_16x16x32_bf16 v[12:15], a[204:207], v[76:79], v[12:15]
    v_mfma_f32_16x16x32_bf16 v[8:11], a[144:147], v[80:83], v[8:11]
    v_mfma_f32_16x16x32_bf16 v[12:15], a[208:211], v[80:83], v[12:15]
    v_mfma_f32_16x16x32_bf16 v[8:11], a[148:151], v[84:87], v[8:11]
    v_mfma_f32_16x16x32_bf16 v[12:15], a[212:215], v[84:87], v[12:15]
    v_mfma_f32_16x16x32_bf16 v[8:11], a[152:155], v[88:91], v[8:11]
    v_mfma_f32_16x16x32_bf16 v[12:15], a[216:219], v[88:91], v[12:15]
    v_mfma_f32_16x16x32_bf16 v[8:11], a[156:159], v[92:95], v[8:11]
    v_mfma_f32_16x16x32_bf16 v[12:15], a[220:223], v[92:95], v[12:15]
    v_mfma_f32_16x16x32_bf16 v[8:11], a[160:163], v[96:99], v[8:11]
    v_mfma_f32_16x16x32_bf16 v[12:15], a[224:227], v[96:99], v[12:15]
    v_mfma_f32_16x16x32_bf16 v[8:11], a[164:167], v[100:103], v[8:11]
    v_mfma_f32_16x16x32_bf16 v[12:15], a[228:231], v[100:103], v[12:15]
    v_mfma_f32_16x16x32_bf16 v[8:11], a[168:171], v[104:107], v[8:11]
    v_mfma_f32_16x16x32_bf16 v[12:15], a[232:235], v[104:107], v[12:15]
    v_mfma_f32_16x16x32_bf16 v[8:11], a[172:175], v[108:111], v[8:11]
    v_mfma_f32_16x16x32_bf16 v[12:15], a[236:239], v[108:111], v[12:15]
    v_mfma_f32_16x16x32_bf16 v[8:11], a[176:179], v[112:115], v[8:11]
    v_mfma_f32_16x16x32_bf16 v[12:15], a[240:243], v[112:115], v[12:15]
    v_mfma_f32_16x16x32_bf16 v[8:11], a[180:183], v[116:119], v[8:11]
    v_mfma_f32_16x16x32_bf16 v[12:15], a[244:247], v[116:119], v[12:15]
    v_mfma_f32_16x16x32_bf16 v[8:11], a[184:187], v[120:123], v[8:11]
    v_mfma_f32_16x16x32_bf16 v[12:15], a[248:251], v[120:123], v[12:15]
    v_mfma_f32_16x16x32_bf16 v[8:11], a[188:191], v[124:127], v[8:11]
    v_mfma_f32_16x16x32_bf16 v[12:15], a[252:255], v[124:127], v[12:15]
    s_nop 7
    v_cvt_pk_bf16_f32 v6, v8, v9
    v_cvt_pk_bf16_f32 v7, v10, v11
    v_mul_u32_u24 v1, 528, v4
    v_lshl_add_u32 v1, v3, 3, v1
    v_cmp_gt_u32 vcc, 8, v4
    s_and_saveexec_b64 s[20:21], vcc
    ds_write_b64 v1, v[6:7] offset:8768
    v_lshlrev_b32 v1, 13, v4
    v_lshl_add_u32 v1, v3, 3, v1
    s_lshl_b32 s22, s12, 16
    s_lshl_b32 s23, s5, 8
    s_add_u32 s22, s22, s23
    s_add_u32 s22, s22, 83886272
    buffer_store_dwordx2 v[6:7], v1, s[48:51], s22 offen
    s_mov_b64 exec, -1
    s_nop 1
    v_cvt_pk_bf16_f32 v6, v12, v13
    v_cvt_pk_bf16_f32 v7, v14, v15
    v_mul_u32_u24 v1, 528, v4
    v_lshl_add_u32 v1, v3, 3, v1
    v_cmp_gt_u32 vcc, 8, v4
    s_and_saveexec_b64 s[20:21], vcc
    ds_write_b64 v1, v[6:7] offset:8800
    v_lshlrev_b32 v1, 13, v4
    v_lshl_add_u32 v1, v3, 3, v1
    s_lshl_b32 s22, s12, 16
    s_lshl_b32 s23, s5, 8
    s_add_u32 s22, s22, s23
    s_add_u32 s22, s22, 83886304
    buffer_store_dwordx2 v[6:7], v1, s[48:51], s22 offen
    s_mov_b64 exec, -1
    s_nop 1
    v_mfma_f32_16x16x32_bf16 v[8:11], v[64:67], v[128:131], 0
    v_mfma_f32_16x16x32_bf16 v[12:15], v[64:67], v[192:195], 0
    v_mfma_f32_16x16x32_bf16 v[8:11], v[68:71], v[132:135], v[8:11]
    v_mfma_f32_16x16x32_bf16 v[12:15], v[68:71], v[196:199], v[12:15]
    v_mfma_f32_16x16x32_bf16 v[8:11], v[72:75], v[136:139], v[8:11]
    v_mfma_f32_16x16x32_bf16 v[12:15], v[72:75], v[200:203], v[12:15]
    v_mfma_f32_16x16x32_bf16 v[8:11], v[76:79], v[140:143], v[8:11]
    v_mfma_f32_16x16x32_bf16 v[12:15], v[76:79], v[204:207], v[12:15]
    v_mfma_f32_16x16x32_bf16 v[8:11], v[80:83], v[144:147], v[8:11]
    v_mfma_f32_16x16x32_bf16 v[12:15], v[80:83], v[208:211], v[12:15]
    v_mfma_f32_16x16x32_bf16 v[8:11], v[84:87], v[148:151], v[8:11]
    v_mfma_f32_16x16x32_bf16 v[12:15], v[84:87], v[212:215], v[12:15]
    v_mfma_f32_16x16x32_bf16 v[8:11], v[88:91], v[152:155], v[8:11]
    v_mfma_f32_16x16x32_bf16 v[12:15], v[88:91], v[216:219], v[12:15]
    v_mfma_f32_16x16x32_bf16 v[8:11], v[92:95], v[156:159], v[8:11]
    v_mfma_f32_16x16x32_bf16 v[12:15], v[92:95], v[220:223], v[12:15]
    v_mfma_f32_16x16x32_bf16 v[8:11], v[96:99], v[160:163], v[8:11]
    v_mfma_f32_16x16x32_bf16 v[12:15], v[96:99], v[224:227], v[12:15]
    v_mfma_f32_16x16x32_bf16 v[8:11], v[100:103], v[164:167], v[8:11]
    v_mfma_f32_16x16x32_bf16 v[12:15], v[100:103], v[228:231], v[12:15]
    v_mfma_f32_16x16x32_bf16 v[8:11], v[104:107], v[168:171], v[8:11]
    v_mfma_f32_16x16x32_bf16 v[12:15], v[104:107], v[232:235], v[12:15]
    v_mfma_f32_16x16x32_bf16 v[8:11], v[108:111], v[172:175], v[8:11]
    v_mfma_f32_16x16x32_bf16 v[12:15], v[108:111], v[236:239], v[12:15]
    v_mfma_f32_16x16x32_bf16 v[8:11], v[112:115], v[176:179], v[8:11]
    v_mfma_f32_16x16x32_bf16 v[12:15], v[112:115], v[240:243], v[12:15]
    v_mfma_f32_16x16x32_bf16 v[8:11], v[116:119], v[180:183], v[8:11]
    v_mfma_f32_16x16x32_bf16 v[12:15], v[116:119], v[244:247], v[12:15]
    v_mfma_f32_16x16x32_bf16 v[8:11], v[120:123], v[184:187], v[8:11]
    v_mfma_f32_16x16x32_bf16 v[12:15], v[120:123], v[248:251], v[12:15]
    v_mfma_f32_16x16x32_bf16 v[8:11], v[124:127], v[188:191], v[8:11]
    v_mfma_f32_16x16x32_bf16 v[12:15], v[124:127], v[252:255], v[12:15]
    s_nop 7
    v_cvt_pk_bf16_f32 v6, v8, v9
    v_cvt_pk_bf16_f32 v7, v10, v11
    v_lshlrev_b32 v1, 4, v4
    v_lshl_add_u32 v1, v3, 3, v1
    v_cmp_gt_u32 vcc, 2, v3
    s_and_saveexec_b64 s[20:21], vcc
    ds_write_b64 v1, v[6:7] offset:12544
    s_lshl_b32 s22, s12, 16
    s_lshl_b32 s23, s5, 11
    s_add_u32 s22, s22, s23
    s_add_u32 s22, s22, 88080384
    buffer_store_dwordx2 v[6:7], v1, s[48:51], s22 offen
    s_mov_b64 exec, -1
    s_nop 1
    v_cvt_pk_bf16_f32 v6, v12, v13
    v_cvt_pk_bf16_f32 v7, v14, v15
    v_lshlrev_b32 v1, 4, v4
    v_lshl_add_u32 v1, v3, 3, v1
    v_cmp_gt_u32 vcc, 2, v3
    s_and_saveexec_b64 s[20:21], vcc
    ds_write_b64 v1, v[6:7] offset:12800
    s_lshl_b32 s22, s12, 16
    s_lshl_b32 s23, s5, 11
    s_add_u32 s22, s22, s23
    s_add_u32 s22, s22, 88080640
    buffer_store_dwordx2 v[6:7], v1, s[48:51], s22 offen
    s_mov_b64 exec, -1
    s_nop 1
    s_branch qe_8
qw_11:
    s_cmp_lg_u32 s3, 3
    s_cbranch_scc1 qw_12
    v_mfma_f32_16x16x32_bf16 v[8:11], v[64:67], a[0:3], 0
    v_mfma_f32_16x16x32_bf16 v[12:15], v[64:67], a[64:67], 0
    v_mfma_f32_16x16x32_bf16 v[8:11], v[68:71], a[4:7], v[8:11]
    v_mfma_f32_16x16x32_bf16 v[12:15], v[68:71], a[68:71], v[12:15]
    v_mfma_f32_16x16x32_bf16 v[8:11], v[72:75], a[8:11], v[8:11]
    v_mfma_f32_16x16x32_bf16 v[12:15], v[72:75], a[72:75], v[12:15]
    v_mfma_f32_16x16x32_bf16 v[8:11], v[76:79], a[12:15], v[8:11]
    v_mfma_f32_16x16x32_bf16 v[12:15], v[76:79], a[76:79], v[12:15]
    v_mfma_f32_16x16x32_bf16 v[8:11], v[80:83], a[16:19], v[8:11]
    v_mfma_f32_16x16x32_bf16 v[12:15], v[80:83], a[80:83], v[12:15]
    v_mfma_f32_16x16x32_bf16 v[8:11], v[84:87], a[20:23], v[8:11]
    v_mfma_f32_16x16x32_bf16 v[12:15], v[84:87], a[84:87], v[12:15]
    v_mfma_f32_16x16x32_bf16 v[8:11], v[88:91], a[24:27], v[8:11]
    v_mfma_f32_16x16x32_bf16 v[12:15], v[88:91], a[88:91], v[12:15]
    v_mfma_f32_16x16x32_bf16 v[8:11], v[92:95], a[28:31], v[8:11]
    v_mfma_f32_16x16x32_bf16 v[12:15], v[92:95], a[92:95], v[12:15]
    v_mfma_f32_16x16x32_bf16 v[8:11], v[96:99], a[32:35], v[8:11]
    v_mfma_f32_16x16x32_bf16 v[12:15], v[96:99], a[96:99], v[12:15]
    v_mfma_f32_16x16x32_bf16 v[8:11], v[100:103], a[36:39], v[8:11]
    v_mfma_f32_16x16x32_bf16 v[12:15], v[100:103], a[100:103], v[12:15]
    v_mfma_f32_16x16x32_bf16 v[8:11], v[104:107], a[40:43], v[8:11]
    v_mfma_f32_16x16x32_bf16 v[12:15], v[104:107], a[104:107], v[12:15]
    v_mfma_f32_16x16x32_bf16 v[8:11], v[108:111], a[44:47], v[8:11]
    v_mfma_f32_16x16x32_bf16 v[12:15], v[108:111], a[108:111], v[12:15]
    v_mfma_f32_16x16x32_bf16 v[8:11], v[112:115], a[48:51], v[8:11]
    v_mfma_f32_16x16x32_bf16 v[12:15], v[112:115], a[112:115], v[12:15]
    v_mfma_f32_16x16x32_bf16 v[8:11], v[116:119], a[52:55], v[8:11]
    v_mfma_f32_16x16x32_bf16 v[12:15], v[116:119], a[116:119], v[12:15]
    v_mfma_f32_16x16x32_bf16 v[8:11], v[120:123], a[56:59], v[8:11]
    v_mfma_f32_16x16x32_bf16 v[12:15], v[120:123], a[120:123], v[12:15]
    v_mfma_f32_16x16x32_bf16 v[8:11], v[124:127], a[60:63], v[8:11]
    v_mfma_f32_16x16x32_bf16 v[12:15], v[124:127], a[124:127], v[12:15]
    s_nop 7
    v_cvt_pk_bf16_f32 v6, v8, v9
    v_cvt_pk_bf16_f32 v7, v10, v11
    v_lshlrev_b32 v1, 4, v4
    v_lshl_add_u32 v1, v3, 3, v1
    v_cmp_gt_u32 vcc, 2, v3
    s_and_saveexec_b64 s[20:21], vcc
    ds_write_b64 v1, v[6:7] offset:13056
    s_lshl_b32 s22, s12, 16
    s_lshl_b32 s23, s5, 11
    s_add_u32 s22, s22, s23
    s_add_u32 s22, s22, 88080896
    buffer_store_dwordx2 v[6:7], v1, s[48:51], s22 offen
    s_mov_b64 exec, -1
    s_nop 1
    v_cvt_pk_bf16_f32 v6, v12, v13
    v_cvt_pk_bf16_f32 v7, v14, v15
    v_lshlrev_b32 v1, 4, v4
    v_lshl_add_u32 v1, v3, 3, v1
    v_cmp_gt_u32 vcc, 2, v3
    s_and_saveexec_b64 s[20:21], vcc
    ds_write_b64 v1, v[6:7] offset:13312
    s_lshl_b32 s22, s12, 16
    s_lshl_b32 s23, s5, 11
    s_add_u32 s22, s22, s23
    s_add_u32 s22, s22, 88081152
    buffer_store_dwordx2 v[6:7], v1, s[48:51], s22 offen
    s_mov_b64 exec, -1
    s_nop 1
    v_mfma_f32_16x16x32_bf16 v[8:11], v[64:67], a[128:131], 0
    v_mfma_f32_16x16x32_bf16 v[12:15], v[64:67], a[192:195], 0
    v_mfma_f32_16x16x32_bf16 v[8:11], v[68:71], a[132:135], v[8:11]
    v_mfma_f32_16x16x32_bf16 v[12:15], v[68:71], a[196:199], v[12:15]
    v_mfma_f32_16x16x32_bf16 v[8:11], v[72:75], a[136:139], v[8:11]
    v_mfma_f32_16x16x32_bf16 v[12:15], v[72:75], a[200:203], v[12:15]
    v_mfma_f32_16x16x32_bf16 v[8:11], v[76:79], a[140:143], v[8:11]
    v_mfma_f32_16x16x32_bf16 v[12:15], v[76:79], a[204:207], v[12:15]
    v_mfma_f32_16x16x32_bf16 v[8:11], v[80:83], a[144:147], v[8:11]
    v_mfma_f32_16x16x32_bf16 v[12:15], v[80:83], a[208:211], v[12:15]
    v_mfma_f32_16x16x32_bf16 v[8:11], v[84:87], a[148:151], v[8:11]
    v_mfma_f32_16x16x32_bf16 v[12:15], v[84:87], a[212:215], v[12:15]
    v_mfma_f32_16x16x32_bf16 v[8:11], v[88:91], a[152:155], v[8:11]
    v_mfma_f32_16x16x32_bf16 v[12:15], v[88:91], a[216:219], v[12:15]
    v_mfma_f32_16x16x32_bf16 v[8:11], v[92:95], a[156:159], v[8:11]
    v_mfma_f32_16x16x32_bf16 v[12:15], v[92:95], a[220:223], v[12:15]
    v_mfma_f32_16x16x32_bf16 v[8:11], v[96:99], a[160:163], v[8:11]
    v_mfma_f32_16x16x32_bf16 v[12:15], v[96:99], a[224:227], v[12:15]
    v_mfma_f32_16x16x32_bf16 v[8:11], v[100:103], a[164:167], v[8:11]
    v_mfma_f32_16x16x32_bf16 v[12:15], v[100:103], a[228:231], v[12:15]
    v_mfma_f32_16x16x32_bf16 v[8:11], v[104:107], a[168:171], v[8:11]
    v_mfma_f32_16x16x32_bf16 v[12:15], v[104:107], a[232:235], v[12:15]
    v_mfma_f32_16x16x32_bf16 v[8:11], v[108:111], a[172:175], v[8:11]
    v_mfma_f32_16x16x32_bf16 v[12:15], v[108:111], a[236:239], v[12:15]
    v_mfma_f32_16x16x32_bf16 v[8:11], v[112:115], a[176:179], v[8:11]
    v_mfma_f32_16x16x32_bf16 v[12:15], v[112:115], a[240:243], v[12:15]
    v_mfma_f32_16x16x32_bf16 v[8:11], v[116:119], a[180:183], v[8:11]
    v_mfma_f32_16x16x32_bf16 v[12:15], v[116:119], a[244:247], v[12:15]
    v_mfma_f32_16x16x32_bf16 v[8:11], v[120:123], a[184:187], v[8:11]
    v_mfma_f32_16x16x32_bf16 v[12:15], v[120:123], a[248:251], v[12:15]
    v_mfma_f32_16x16x32_bf16 v[8:11], v[124:127], a[188:191], v[8:11]
    v_mfma_f32_16x16x32_bf16 v[12:15], v[124:127], a[252:255], v[12:15]
    s_nop 7
    v_cvt_pk_bf16_f32 v6, v8, v9
    v_cvt_pk_bf16_f32 v7, v10, v11
    v_lshlrev_b32 v1, 4, v4
    v_lshl_add_u32 v1, v3, 3, v1
    v_cmp_gt_u32 vcc, 2, v3
    s_and_saveexec_b64 s[20:21], vcc
    ds_write_b64 v1, v[6:7] offset:13568
    s_lshl_b32 s22, s12, 16
    s_lshl_b32 s23, s5, 11
    s_add_u32 s22, s22, s23
    s_add_u32 s22, s22, 88081408
    buffer_store_dwordx2 v[6:7], v1, s[48:51], s22 offen
    s_mov_b64 exec, -1
    s_nop 1
    v_cvt_pk_bf16_f32 v6, v12, v13
    v_cvt_pk_bf16_f32 v7, v14, v15
    v_lshlrev_b32 v1, 4, v4
    v_lshl_add_u32 v1, v3, 3, v1
    v_cmp_gt_u32 vcc, 2, v3
    s_and_saveexec_b64 s[20:21], vcc
    ds_write_b64 v1, v[6:7] offset:13824
    s_lshl_b32 s22, s12, 16
    s_lshl_b32 s23, s5, 11
    s_add_u32 s22, s22, s23
    s_add_u32 s22, s22, 88081664
    buffer_store_dwordx2 v[6:7], v1, s[48:51], s22 offen
    s_mov_b64 exec, -1
    s_nop 1
    v_mfma_f32_16x16x32_bf16 v[8:11], v[64:67], v[128:131], 0
    v_mfma_f32_16x16x32_bf16 v[12:15], v[64:67], v[192:195], 0
    v_mfma_f32_16x16x32_bf16 v[8:11], v[68:71], v[132:135], v[8:11]
    v_mfma_f32_16x16x32_bf16 v[12:15], v[68:71], v[196:199], v[12:15]
    v_mfma_f32_16x16x32_bf16 v[8:11], v[72:75], v[136:139], v[8:11]
    v_mfma_f32_16x16x32_bf16 v[12:15], v[72:75], v[200:203], v[12:15]
    v_mfma_f32_16x16x32_bf16 v[8:11], v[76:79], v[140:143], v[8:11]
    v_mfma_f32_16x16x32_bf16 v[12:15], v[76:79], v[204:207], v[12:15]
    v_mfma_f32_16x16x32_bf16 v[8:11], v[80:83], v[144:147], v[8:11]
    v_mfma_f32_16x16x32_bf16 v[12:15], v[80:83], v[208:211], v[12:15]
    v_mfma_f32_16x16x32_bf16 v[8:11], v[84:87], v[148:151], v[8:11]
    v_mfma_f32_16x16x32_bf16 v[12:15], v[84:87], v[212:215], v[12:15]
    v_mfma_f32_16x16x32_bf16 v[8:11], v[88:91], v[152:155], v[8:11]
    v_mfma_f32_16x16x32_bf16 v[12:15], v[88:91], v[216:219], v[12:15]
    v_mfma_f32_16x16x32_bf16 v[8:11], v[92:95], v[156:159], v[8:11]
    v_mfma_f32_16x16x32_bf16 v[12:15], v[92:95], v[220:223], v[12:15]
    v_mfma_f32_16x16x32_bf16 v[8:11], v[96:99], v[160:163], v[8:11]
    v_mfma_f32_16x16x32_bf16 v[12:15], v[96:99], v[224:227], v[12:15]
    v_mfma_f32_16x16x32_bf16 v[8:11], v[100:103], v[164:167], v[8:11]
    v_mfma_f32_16x16x32_bf16 v[12:15], v[100:103], v[228:231], v[12:15]
    v_mfma_f32_16x16x32_bf16 v[8:11], v[104:107], v[168:171], v[8:11]
    v_mfma_f32_16x16x32_bf16 v[12:15], v[104:107], v[232:235], v[12:15]
    v_mfma_f32_16x16x32_bf16 v[8:11], v[108:111], v[172:175], v[8:11]
    v_mfma_f32_16x16x32_bf16 v[12:15], v[108:111], v[236:239], v[12:15]
    v_mfma_f32_16x16x32_bf16 v[8:11], v[112:115], v[176:179], v[8:11]
    v_mfma_f32_16x16x32_bf16 v[12:15], v[112:115], v[240:243], v[12:15]
    v_mfma_f32_16x16x32_bf16 v[8:11], v[116:119], v[180:183], v[8:11]
    v_mfma_f32_16x16x32_bf16 v[12:15], v[116:119], v[244:247], v[12:15]
    v_mfma_f32_16x16x32_bf16 v[8:11], v[120:123], v[184:187], v[8:11]
    v_mfma_f32_16x16x32_bf16 v[12:15], v[120:123], v[248:251], v[12:15]
    v_mfma_f32_16x16x32_bf16 v[8:11], v[124:127], v[188:191], v[8:11]
    v_mfma_f32_16x16x32_bf16 v[12:15], v[124:127], v[252:255], v[12:15]
    s_nop 7
    v_cvt_pk_bf16_f32 v6, v8, v9
    v_cvt_pk_bf16_f32 v7, v10, v11
    v_lshlrev_b32 v1, 4, v4
    v_lshl_add_u32 v1, v3, 3, v1
    v_cmp_gt_u32 vcc, 2, v3
    s_and_saveexec_b64 s[20:21], vcc
    ds_write_b64 v1, v[6:7] offset:14080
    s_lshl_b32 s22, s12, 16
    s_lshl_b32 s23, s5, 11
    s_add_u32 s22, s22, s23
    s_add_u32 s22, s22, 88081920
    buffer_store_dwordx2 v[6:7], v1, s[48:51], s22 offen
    s_mov_b64 exec, -1
    s_nop 1
    v_cvt_pk_bf16_f32 v6, v12, v13
    v_cvt_pk_bf16_f32 v7, v14, v15
    v_lshlrev_b32 v1, 4, v4
    v_lshl_add_u32 v1, v3, 3, v1
    v_cmp_gt_u32 vcc, 2, v3
    s_and_saveexec_b64 s[20:21], vcc
    ds_write_b64 v1, v[6:7] offset:14336
    s_lshl_b32 s22, s12, 16
    s_lshl_b32 s23, s5, 11
    s_add_u32 s22, s22, s23
    s_add_u32 s22, s22, 88082176
    buffer_store_dwordx2 v[6:7], v1, s[48:51], s22 offen
    s_mov_b64 exec, -1
    s_nop 1
    s_branch qe_8
qw_12:
qe_8:
    s_cmp_eq_u32 s12, 63
    s_cbranch_scc1 k3_end
    s_waitcnt lgkmcnt(0)
    s_barrier
    v_mul_u32_u24 v8, 528, v5
    v_lshl_add_u32 v8, v3, 4, v8
    v_add_u32 v8, 8320, v8
    ds_read_b128 v[64:67], v8 offset:0
    ds_read_b128 v[80:83], v8 offset:256
    ds_read_b128 v[68:71], v8 offset:64
    ds_read_b128 v[84:87], v8 offset:320
    ds_read_b128 v[72:75], v8 offset:128
    ds_read_b128 v[88:91], v8 offset:384
    ds_read_b128 v[76:79], v8 offset:192
    ds_read_b128 v[92:95], v8 offset:448
    v_lshlrev_b32 v8, 4, v4
    v_lshl_add_u32 v8, v3, 3, v8
    s_lshl_b32 s15, s3, 9
    v_add_u32 v8, s15, v8
    ds_read_b64 v[24:25], v8 offset:12544
    ds_read_b64 v[28:29], v8 offset:12800
    v_mov_b32 v26, 0
    v_mov_b32 v27, 0
    v_mov_b32 v30, 0
    v_mov_b32 v31, 0
    s_waitcnt vmcnt(0) lgkmcnt(0)
    v_cmp_gt_u32 vcc, 2, v3
    s_nop 1
    v_cndmask_b32 v24, 0, v24, vcc
    v_cndmask_b32 v25, 0, v25, vcc
    v_cndmask_b32 v28, 0, v28, vcc
    v_cndmask_b32 v29, 0, v29, vcc
    v_mfma_f32_16x16x32_bf16 v[96:99], v[80:83], v[64:67], 0
    v_mfma_f32_16x16x32_bf16 v[96:99], v[84:87], v[68:71], v[96:99]
    v_mfma_f32_16x16x32_bf16 v[96:99], v[88:91], v[72:75], v[96:99]
    v_mfma_f32_16x16x32_bf16 v[96:99], v[92:95], v[76:79], v[96:99]
    v_mfma_f32_16x16x32_bf16 v[100:103], v[32:35], v[64:67], 0
    v_mfma_f32_16x16x32_bf16 v[100:103], v[36:39], v[68:71], v[100:103]
    v_mfma_f32_16x16x32_bf16 v[100:103], v[40:43], v[72:75], v[100:103]
    v_mfma_f32_16x16x32_bf16 v[100:103], v[44:47], v[76:79], v[100:103]
    v_mfma_f32_16x16x32_bf16 v[104:107], v[48:51], v[64:67], 0
    v_mfma_f32_16x16x32_bf16 v[104:107], v[52:55], v[68:71], v[104:107]
    v_mfma_f32_16x16x32_bf16 v[104:107], v[56:59], v[72:75], v[104:107]
    v_mfma_f32_16x16x32_bf16 v[104:107], v[60:63], v[76:79], v[104:107]
    s_nop 7
    v_cmp_gt_u32 vcc, 2, v3
    v_mov_b32 v8, 0xff800000
    s_nop 1
    v_cndmask_b32 v96, v8, v96, vcc
    v_cndmask_b32 v97, v8, v97, vcc
    v_cndmask_b32 v98, v8, v98, vcc
    v_cndmask_b32 v99, v8, v99, vcc
    v_max_f32 v9, v96, v97
    v_max_f32 v9, v9, v98
    v_max_f32 v9, v9, v99
    v_max_f32 v9, v9, v100
    v_max_f32 v9, v9, v101
    v_max_f32 v9, v9, v102
    v_max_f32 v9, v9, v103
    v_max_f32 v9, v9, v104
    v_max_f32 v9, v9, v105
    v_max_f32 v9, v9, v106
    v_max_f32 v9, v9, v107
    v_xor_b32 v10, 16, v2
    v_lshlrev_b32 v10, 2, v10
    v_xor_b32 v11, 32, v2
    v_lshlrev_b32 v11, 2, v11
    ds_bpermute_b32 v12, v10, v9
    s_waitcnt lgkmcnt(0)
    v_max_f32 v9, v9, v12
    ds_bpermute_b32 v12, v11, v9
    s_waitcnt lgkmcnt(0)
    v_max_f32 v9, v9, v12
    s_mov_b32 s24, 0x3e029e1e
    v_sub_f32 v96, v96, v9
    v_mul_f32 v96, s24, v96
    v_exp_f32 v96, v96
    v_sub_f32 v97, v97, v9
    v_mul_f32 v97, s24, v97
    v_exp_f32 v97, v97
    v_sub_f32 v98, v98, v9
    v_mul_f32 v98, s24, v98
    v_exp_f32 v98, v98
    v_sub_f32 v99, v99, v9
    v_mul_f32 v99, s24, v99
    v_exp_f32 v99, v99
    v_sub_f32 v100, v100, v9
    v_mul_f32 v100, s24, v100
    v_exp_f32 v100, v100
    v_sub_f32 v101, v101, v9
    v_mul_f32 v101, s24, v101
    v_exp_f32 v101, v101
    v_sub_f32 v102, v102, v9
    v_mul_f32 v102, s24, v102
    v_exp_f32 v102, v102
    v_sub_f32 v103, v103, v9
    v_mul_f32 v103, s24, v103
    v_exp_f32 v103, v103
    v_sub_f32 v104, v104, v9
    v_mul_f32 v104, s24, v104
    v_exp_f32 v104, v104
    v_sub_f32 v105, v105, v9
    v_mul_f32 v105, s24, v105
    v_exp_f32 v105, v105
    v_sub_f32 v106, v106, v9
    v_mul_f32 v106, s24, v106
    v_exp_f32 v106, v106
    v_sub_f32 v107, v107, v9
    v_mul_f32 v107, s24, v107
    v_exp_f32 v107, v107
    s_nop 0
    v_add_f32 v9, v96, v97
    v_add_f32 v9, v9, v98
    v_add_f32 v9, v9, v99
    v_add_f32 v9, v9, v100
    v_add_f32 v9, v9, v101
    v_add_f32 v9, v9, v102
    v_add_f32 v9, v9, v103
    v_add_f32 v9, v9, v104
    v_add_f32 v9, v9, v105
    v_add_f32 v9, v9, v106
    v_add_f32 v9, v9, v107
    ds_bpermute_b32 v12, v10, v9
    s_waitcnt lgkmcnt(0)
    v_add_f32 v9, v9, v12
    ds_bpermute_b32 v12, v11, v9
    s_waitcnt lgkmcnt(0)
    v_add_f32 v9, v9, v12
    v_rcp_f32 v9, v9
    s_nop 0
    v_mul_f32 v96, v96, v9
    v_mul_f32 v97, v97, v9
    v_mul_f32 v98, v98, v9
    v_mul_f32 v99, v99, v9
    v_mul_f32 v100, v100, v9
    v_mul_f32 v101, v101, v9
    v_mul_f32 v102, v102, v9
    v_mul_f32 v103, v103, v9
    v_mul_f32 v104, v104, v9
    v_mul_f32 v105, v105, v9
    v_mul_f32 v106, v106, v9
    v_mul_f32 v107, v107, v9
    v_cvt_pk_bf16_f32 v108, v100, v101
    v_cvt_pk_bf16_f32 v109, v102, v103
    v_cvt_pk_bf16_f32 v110, v104, v105
    v_cvt_pk_bf16_f32 v111, v106, v107
    v_cvt_pk_bf16_f32 v112, v96, v97
    v_cvt_pk_bf16_f32 v113, v98, v99
    v_mov_b32 v114, 0
    v_mov_b32 v115, 0
    s_nop 1
    v_mfma_f32_16x16x32_bf16 v[116:119], v[16:19], v[108:111], 0
    v_mfma_f32_16x16x32_bf16 v[116:119], v[24:27], v[112:115], v[116:119]
    v_mfma_f32_16x16x32_bf16 v[120:123], v[20:23], v[108:111], 0
    v_mfma_f32_16x16x32_bf16 v[120:123], v[28:31], v[112:115], v[120:123]
    s_nop 7
    s_nop 1
    v_mul_u32_u24 v8, 272, v4
    v_lshl_add_u32 v8, v3, 3, v8
    s_lshl_b32 s15, s3, 6
    v_add_u32 v8, s15, v8
    v_cmp_gt_u32 vcc, 8, v4
    s_and_saveexec_b64 s[20:21], vcc
    v_cvt_pk_bf16_f32 v12, v116, v117
    v_cvt_pk_bf16_f32 v13, v118, v119
    ds_write_b64 v8, v[12:13] offset:14592
    v_cvt_pk_bf16_f32 v12, v120, v121
    v_cvt_pk_bf16_f32 v13, v122, v123
    ds_write_b64 v8, v[12:13] offset:14624
    s_mov_b64 exec, -1
    s_waitcnt lgkmcnt(0)
    s_barrier
    v_mul_u32_u24 v8, 272, v5
    v_lshl_add_u32 v8, v3, 3, v8
    v_add_u32 v8, 14592, v8
    ds_read_b64 v[64:65], v8 offset:0
    ds_read_b64 v[66:67], v8 offset:32
    ds_read_b64 v[68:69], v8 offset:64
    ds_read_b64 v[70:71], v8 offset:96
    ds_read_b64 v[72:73], v8 offset:128
    ds_read_b64 v[74:75], v8 offset:160
    ds_read_b64 v[76:77], v8 offset:192
    ds_read_b64 v[78:79], v8 offset:224
    s_lshl_b32 s15, s3, 15
    s_add_u32 s15, s15, 20480
    v_lshlrev_b32 v9, 4, v2
    v_add_u32 v9, s15, v9
    s_and_b32 s16, s12, 1
    s_lshl_b32 s16, s16, 5
    s_add_u32 s16, s16, s5
    s_lshl_b32 s16, s16, 15
    s_lshl_b32 s17, s3, 10
    s_add_u32 s16, s16, s17
    s_add_u32 s16, s16, 117440512
    s_add_u32 s18, s12, 1
    v_lshlrev_b32 v10, 12, v4
    v_lshl_add_u32 v10, v3, 5, v10
    ds_read_b128 v[80:83], v9 offset:0
    ds_read_b128 v[84:87], v9 offset:1024
    ds_read_b128 v[88:91], v9 offset:2048
    ds_read_b128 v[92:95], v9 offset:3072
    ds_read_b128 v[96:99], v9 offset:4096
    ds_read_b128 v[100:103], v9 offset:5120
    ds_read_b128 v[104:107], v9 offset:6144
    ds_read_b128 v[108:111], v9 offset:7168
    s_waitcnt lgkmcnt(0)
    v_mfma_f32_16x16x32_bf16 v[112:115], v[80:83], v[64:67], 0
    v_mfma_f32_16x16x32_bf16 v[116:119], v[96:99], v[64:67], 0
    v_mfma_f32_16x16x32_bf16 v[112:115], v[84:87], v[68:71], v[112:115]
    v_mfma_f32_16x16x32_bf16 v[116:119], v[100:103], v[68:71], v[116:119]
    v_mfma_f32_16x16x32_bf16 v[112:115], v[88:91], v[72:75], v[112:115]
    v_mfma_f32_16x16x32_bf16 v[116:119], v[104:107], v[72:75], v[116:119]
    v_mfma_f32_16x16x32_bf16 v[112:115], v[92:95], v[76:79], v[112:115]
    v_mfma_f32_16x16x32_bf16 v[116:119], v[108:111], v[76:79], v[116:119]
    s_nop 7
    v_cmp_gt_u32 vcc, 8, v4
    s_and_saveexec_b64 s[20:21], vcc
    v_mov_b32 v120, v112
    v_mov_b32 v121, s18
    v_mov_b32 v122, v113
    v_mov_b32 v123, s18
    v_mov_b32 v124, v114
    v_mov_b32 v125, s18
    v_mov_b32 v126, v115
    v_mov_b32 v127, s18
    s_cmp_eq_u32 s60, 0
    s_cbranch_scc0 sl_13
    buffer_store_dwordx4 v[120:123], v10, s[48:51], s16 offen offset:0
    buffer_store_dwordx4 v[124:127], v10, s[48:51], s16 offen offset:16
    s_branch sl_14
sl_13:
    buffer_store_dwordx4 v[120:123], v10, s[48:51], s16 offen offset:0 sc1
    buffer_store_dwordx4 v[124:127], v10, s[48:51], s16 offen offset:16 sc1
sl_14:
    s_nop 1
    v_mov_b32 v120, v116
    v_mov_b32 v121, s18
    v_mov_b32 v122, v117
    v_mov_b32 v123, s18
    v_mov_b32 v124, v118
    v_mov_b32 v125, s18
    v_mov_b32 v126, v119
    v_mov_b32 v127, s18
    s_cmp_eq_u32 s60, 0
    s_cbranch_scc0 sl_15
    buffer_store_dwordx4 v[120:123], v10, s[48:51], s16 offen offset:128
    buffer_store_dwordx4 v[124:127], v10, s[48:51], s16 offen offset:144
    s_branch sl_16
sl_15:
    buffer_store_dwordx4 v[120:123], v10, s[48:51], s16 offen offset:128 sc1
    buffer_store_dwordx4 v[124:127], v10, s[48:51], s16 offen offset:144 sc1
sl_16:
    s_nop 1
    s_mov_b64 exec, -1
    ds_read_b128 v[80:83], v9 offset:8192
    ds_read_b128 v[84:87], v9 offset:9216
    ds_read_b128 v[88:91], v9 offset:10240
    ds_read_b128 v[92:95], v9 offset:11264
    ds_read_b128 v[96:99], v9 offset:12288
    ds_read_b128 v[100:103], v9 offset:13312
    ds_read_b128 v[104:107], v9 offset:14336
    ds_read_b128 v[108:111], v9 offset:15360
    s_waitcnt lgkmcnt(0)
    v_mfma_f32_16x16x32_bf16 v[112:115], v[80:83], v[64:67], 0
    v_mfma_f32_16x16x32_bf16 v[116:119], v[96:99], v[64:67], 0
    v_mfma_f32_16x16x32_bf16 v[112:115], v[84:87], v[68:71], v[112:115]
    v_mfma_f32_16x16x32_bf16 v[116:119], v[100:103], v[68:71], v[116:119]
    v_mfma_f32_16x16x32_bf16 v[112:115], v[88:91], v[72:75], v[112:115]
    v_mfma_f32_16x16x32_bf16 v[116:119], v[104:107], v[72:75], v[116:119]
    v_mfma_f32_16x16x32_bf16 v[112:115], v[92:95], v[76:79], v[112:115]
    v_mfma_f32_16x16x32_bf16 v[116:119], v[108:111], v[76:79], v[116:119]
    s_nop 7
    v_cmp_gt_u32 vcc, 8, v4
    s_and_saveexec_b64 s[20:21], vcc
    v_mov_b32 v120, v112
    v_mov_b32 v121, s18
    v_mov_b32 v122, v113
    v_mov_b32 v123, s18
    v_mov_b32 v124, v114
    v_mov_b32 v125, s18
    v_mov_b32 v126, v115
    v_mov_b32 v127, s18
    s_cmp_eq_u32 s60, 0
    s_cbranch_scc0 sl_17
    buffer_store_dwordx4 v[120:123], v10, s[48:51], s16 offen offset:256
    buffer_store_dwordx4 v[124:127], v10, s[48:51], s16 offen offset:272
    s_branch sl_18
sl_17:
    buffer_store_dwordx4 v[120:123], v10, s[48:51], s16 offen offset:256 sc1
    buffer_store_dwordx4 v[124:127], v10, s[48:51], s16 offen offset:272 sc1
sl_18:
    s_nop 1
    v_mov_b32 v120, v116
    v_mov_b32 v121, s18
    v_mov_b32 v122, v117
    v_mov_b32 v123, s18
    v_mov_b32 v124, v118
    v_mov_b32 v125, s18
    v_mov_b32 v126, v119
    v_mov_b32 v127, s18
    s_cmp_eq_u32 s60, 0
    s_cbranch_scc0 sl_19
    buffer_store_dwordx4 v[120:123], v10, s[48:51], s16 offen offset:384
    buffer_store_dwordx4 v[124:127], v10, s[48:51], s16 offen offset:400
    s_branch sl_20
sl_19:
    buffer_store_dwordx4 v[120:123], v10, s[48:51], s16 offen offset:384 sc1
    buffer_store_dwordx4 v[124:127], v10, s[48:51], s16 offen offset:400 sc1
sl_20:
    s_nop 1
    s_mov_b64 exec, -1
    ds_read_b128 v[80:83], v9 offset:16384
    ds_read_b128 v[84:87], v9 offset:17408
    ds_read_b128 v[88:91], v9 offset:18432
    ds_read_b128 v[92:95], v9 offset:19456
    ds_read_b128 v[96:99], v9 offset:20480
    ds_read_b128 v[100:103], v9 offset:21504
    ds_read_b128 v[104:107], v9 offset:22528
    ds_read_b128 v[108:111], v9 offset:23552
    s_waitcnt lgkmcnt(0)
    v_mfma_f32_16x16x32_bf16 v[112:115], v[80:83], v[64:67], 0
    v_mfma_f32_16x16x32_bf16 v[116:119], v[96:99], v[64:67], 0
    v_mfma_f32_16x16x32_bf16 v[112:115], v[84:87], v[68:71], v[112:115]
    v_mfma_f32_16x16x32_bf16 v[116:119], v[100:103], v[68:71], v[116:119]
    v_mfma_f32_16x16x32_bf16 v[112:115], v[88:91], v[72:75], v[112:115]
    v_mfma_f32_16x16x32_bf16 v[116:119], v[104:107], v[72:75], v[116:119]
    v_mfma_f32_16x16x32_bf16 v[112:115], v[92:95], v[76:79], v[112:115]
    v_mfma_f32_16x16x32_bf16 v[116:119], v[108:111], v[76:79], v[116:119]
    s_nop 7
    v_cmp_gt_u32 vcc, 8, v4
    s_and_saveexec_b64 s[20:21], vcc
    v_mov_b32 v120, v112
    v_mov_b32 v121, s18
    v_mov_b32 v122, v113
    v_mov_b32 v123, s18
    v_mov_b32 v124, v114
    v_mov_b32 v125, s18
    v_mov_b32 v126, v115
    v_mov_b32 v127, s18
    s_cmp_eq_u32 s60, 0
    s_cbranch_scc0 sl_21
    buffer_store_dwordx4 v[120:123], v10, s[48:51], s16 offen offset:512
    buffer_store_dwordx4 v[124:127], v10, s[48:51], s16 offen offset:528
    s_branch sl_22
sl_21:
    buffer_store_dwordx4 v[120:123], v10, s[48:51], s16 offen offset:512 sc1
    buffer_store_dwordx4 v[124:127], v10, s[48:51], s16 offen offset:528 sc1
sl_22:
    s_nop 1
    v_mov_b32 v120, v116
    v_mov_b32 v121, s18
    v_mov_b32 v122, v117
    v_mov_b32 v123, s18
    v_mov_b32 v124, v118
    v_mov_b32 v125, s18
    v_mov_b32 v126, v119
    v_mov_b32 v127, s18
    s_cmp_eq_u32 s60, 0
    s_cbranch_scc0 sl_23
    buffer_store_dwordx4 v[120:123], v10, s[48:51], s16 offen offset:640
    buffer_store_dwordx4 v[124:127], v10, s[48:51], s16 offen offset:656
    s_branch sl_24
sl_23:
    buffer_store_dwordx4 v[120:123], v10, s[48:51], s16 offen offset:640 sc1
    buffer_store_dwordx4 v[124:127], v10, s[48:51], s16 offen offset:656 sc1
sl_24:
    s_nop 1
    s_mov_b64 exec, -1
    ds_read_b128 v[80:83], v9 offset:24576
    ds_read_b128 v[84:87], v9 offset:25600
    ds_read_b128 v[88:91], v9 offset:26624
    ds_read_b128 v[92:95], v9 offset:27648
    ds_read_b128 v[96:99], v9 offset:28672
    ds_read_b128 v[100:103], v9 offset:29696
    ds_read_b128 v[104:107], v9 offset:30720
    ds_read_b128 v[108:111], v9 offset:31744
    s_waitcnt lgkmcnt(0)
    v_mfma_f32_16x16x32_bf16 v[112:115], v[80:83], v[64:67], 0
    v_mfma_f32_16x16x32_bf16 v[116:119], v[96:99], v[64:67], 0
    v_mfma_f32_16x16x32_bf16 v[112:115], v[84:87], v[68:71], v[112:115]
    v_mfma_f32_16x16x32_bf16 v[116:119], v[100:103], v[68:71], v[116:119]
    v_mfma_f32_16x16x32_bf16 v[112:115], v[88:91], v[72:75], v[112:115]
    v_mfma_f32_16x16x32_bf16 v[116:119], v[104:107], v[72:75], v[116:119]
    v_mfma_f32_16x16x32_bf16 v[112:115], v[92:95], v[76:79], v[112:115]
    v_mfma_f32_16x16x32_bf16 v[116:119], v[108:111], v[76:79], v[116:119]
    s_nop 7
    v_cmp_gt_u32 vcc, 8, v4
    s_and_saveexec_b64 s[20:21], vcc
    v_mov_b32 v120, v112
    v_mov_b32 v121, s18
    v_mov_b32 v122, v113
    v_mov_b32 v123, s18
    v_mov_b32 v124, v114
    v_mov_b32 v125, s18
    v_mov_b32 v126, v115
    v_mov_b32 v127, s18
    s_cmp_eq_u32 s60, 0
    s_cbranch_scc0 sl_25
    buffer_store_dwordx4 v[120:123], v10, s[48:51], s16 offen offset:768
    buffer_store_dwordx4 v[124:127], v10, s[48:51], s16 offen offset:784
    s_branch sl_26
sl_25:
    buffer_store_dwordx4 v[120:123], v10, s[48:51], s16 offen offset:768 sc1
    buffer_store_dwordx4 v[124:127], v10, s[48:51], s16 offen offset:784 sc1
sl_26:
    s_nop 1
    v_mov_b32 v120, v116
    v_mov_b32 v121, s18
    v_mov_b32 v122, v117
    v_mov_b32 v123, s18
    v_mov_b32 v124, v118
    v_mov_b32 v125, s18
    v_mov_b32 v126, v119
    v_mov_b32 v127, s18
    s_cmp_eq_u32 s60, 0
    s_cbranch_scc0 sl_27
    buffer_store_dwordx4 v[120:123], v10, s[48:51], s16 offen offset:896
    buffer_store_dwordx4 v[124:127], v10, s[48:51], s16 offen offset:912
    s_branch sl_28
sl_27:
    buffer_store_dwordx4 v[120:123], v10, s[48:51], s16 offen offset:896 sc1
    buffer_store_dwordx4 v[124:127], v10, s[48:51], s16 offen offset:912 sc1
sl_28:
    s_nop 1
    s_mov_b64 exec, -1
    v_lshrrev_b32 v8, 3, v2
    v_lshlrev_b32 v8, 12, v8
    v_lshl_add_u32 v8, v5, 4, v8
    s_and_b32 s16, s12, 1
    s_lshl_b32 s16, s16, 5
    s_lshl_b32 s17, s3, 3
    s_add_u32 s16, s16, s17
    s_lshl_b32 s16, s16, 15
    s_lshl_b32 s17, s5, 7
    s_add_u32 s16, s16, s17
    s_add_u32 s16, s16, 117440512
p1_29:
    s_add_u32 s17, s16, 0
    buffer_load_dwordx4 v[64:67], v8, s[48:51], s17 offen sc1
    s_add_u32 s17, s16, 32768
    buffer_load_dwordx4 v[68:71], v8, s[48:51], s17 offen sc1
    s_add_u32 s17, s16, 65536
    buffer_load_dwordx4 v[72:75], v8, s[48:51], s17 offen sc1
    s_add_u32 s17, s16, 98304
    buffer_load_dwordx4 v[76:79], v8, s[48:51], s17 offen sc1
    s_add_u32 s17, s16, 131072
    buffer_load_dwordx4 v[80:83], v8, s[48:51], s17 offen sc1
    s_add_u32 s17, s16, 163840
    buffer_load_dwordx4 v[84:87], v8, s[48:51], s17 offen sc1
    s_add_u32 s17, s16, 196608
    buffer_load_dwordx4 v[88:91], v8, s[48:51], s17 offen sc1
    s_add_u32 s17, s16, 229376
    buffer_load_dwordx4 v[92:95], v8, s[48:51], s17 offen sc1
    s_waitcnt vmcnt(0)
    s_mov_b64 s[22:23], -1
    v_cmp_eq_u32 vcc, s18, v65
    s_and_b64 s[22:23], s[22:23], vcc
    v_cmp_eq_u32 vcc, s18, v67
    s_and_b64 s[22:23], s[22:23], vcc
    v_cmp_eq_u32 vcc, s18, v69
    s_and_b64 s[22:23], s[22:23], vcc
    v_cmp_eq_u32 vcc, s18, v71
    s_and_b64 s[22:23], s[22:23], vcc
    v_cmp_eq_u32 vcc, s18, v73
    s_and_b64 s[22:23], s[22:23], vcc
    v_cmp_eq_u32 vcc, s18, v75
    s_and_b64 s[22:23], s[22:23], vcc
    v_cmp_eq_u32 vcc, s18, v77
    s_and_b64 s[22:23], s[22:23], vcc
    v_cmp_eq_u32 vcc, s18, v79
    s_and_b64 s[22:23], s[22:23], vcc
    v_cmp_eq_u32 vcc, s18, v81
    s_and_b64 s[22:23], s[22:23], vcc
    v_cmp_eq_u32 vcc, s18, v83
    s_and_b64 s[22:23], s[22:23], vcc
    v_cmp_eq_u32 vcc, s18, v85
    s_and_b64 s[22:23], s[22:23], vcc
    v_cmp_eq_u32 vcc, s18, v87
    s_and_b64 s[22:23], s[22:23], vcc
    v_cmp_eq_u32 vcc, s18, v89
    s_and_b64 s[22:23], s[22:23], vcc
    v_cmp_eq_u32 vcc, s18, v91
    s_and_b64 s[22:23], s[22:23], vcc
    v_cmp_eq_u32 vcc, s18, v93
    s_and_b64 s[22:23], s[22:23], vcc
    v_cmp_eq_u32 vcc, s18, v95
    s_and_b64 s[22:23], s[22:23], vcc
    s_cmp_eq_u64 s[22:23], -1
    s_cbranch_scc0 p1_29
    v_add_f32 v20, v64, v68
    v_add_f32 v21, v66, v70
    v_add_f32 v20, v20, v72
    v_add_f32 v21, v21, v74
    v_add_f32 v20, v20, v76
    v_add_f32 v21, v21, v78
    v_add_f32 v20, v20, v80
    v_add_f32 v21, v21, v82
    v_add_f32 v20, v20, v84
    v_add_f32 v21, v21, v86
    v_add_f32 v20, v20, v88
    v_add_f32 v21, v21, v90
    v_add_f32 v20, v20, v92
    v_add_f32 v21, v21, v94
    v_lshlrev_b32 v11, 3, v0
    ds_write_b64 v11, v[20:21] offset:16768
    s_waitcnt lgkmcnt(0)
    s_barrier
    v_lshlrev_b32 v11, 3, v2
    ds_read_b64 v[12:13], v11 offset:16768
    ds_read_b64 v[14:15], v11 offset:17280
    ds_read_b64 v[16:17], v11 offset:17792
    ds_read_b64 v[18:19], v11 offset:18304
    s_waitcnt lgkmcnt(0)
    v_add_f32 v12, v12, v14
    v_add_f32 v13, v13, v15
    v_add_f32 v12, v12, v16
    v_add_f32 v13, v13, v17
    v_add_f32 v12, v12, v18
    v_add_f32 v13, v13, v19
    v_cvt_pk_bf16_f32 v12, v12, v13
    v_mov_b32 v13, s18
    s_and_b32 s16, s12, 1
    s_lshl_b32 s16, s16, 5
    s_add_u32 s17, s16, s5
    s_lshl_b32 s17, s17, 9
    s_add_u32 s17, s17, 119537664
    s_cmp_lg_u32 s3, 0
    s_cbranch_scc1 sk_30
    s_cmp_eq_u32 s60, 0
    s_cbranch_scc0 sl_31
    buffer_store_dwordx2 v[12:13], v11, s[48:51], s17 offen
    s_branch sl_32
sl_31:
    buffer_store_dwordx2 v[12:13], v11, s[48:51], s17 offen sc1
sl_32:
sk_30:
    v_lshlrev_b32 v8, 6, v0
    s_lshl_b32 s16, s16, 9
    s_add_u32 s16, s16, 119537664
p2_33:
    buffer_load_dwordx4 v[64:67], v8, s[48:51], s16 offen offset:0 sc1
    buffer_load_dwordx4 v[68:71], v8, s[48:51], s16 offen offset:16 sc1
    buffer_load_dwordx4 v[72:75], v8, s[48:51], s16 offen offset:32 sc1
    buffer_load_dwordx4 v[76:79], v8, s[48:51], s16 offen offset:48 sc1
    s_waitcnt vmcnt(0)
    s_mov_b64 s[22:23], -1
    v_cmp_eq_u32 vcc, s18, v65
    s_and_b64 s[22:23], s[22:23], vcc
    v_cmp_eq_u32 vcc, s18, v67
    s_and_b64 s[22:23], s[22:23], vcc
    v_cmp_eq_u32 vcc, s18, v69
    s_and_b64 s[22:23], s[22:23], vcc
    v_cmp_eq_u32 vcc, s18, v71
    s_and_b64 s[22:23], s[22:23], vcc
    v_cmp_eq_u32 vcc, s18, v73
    s_and_b64 s[22:23], s[22:23], vcc
    v_cmp_eq_u32 vcc, s18, v75
    s_and_b64 s[22:23], s[22:23], vcc
    v_cmp_eq_u32 vcc, s18, v77
    s_and_b64 s[22:23], s[22:23], vcc
    v_cmp_eq_u32 vcc, s18, v79
    s_and_b64 s[22:23], s[22:23], vcc
    s_cmp_eq_u64 s[22:23], -1
    s_cbranch_scc0 p2_33
    v_mov_b32 v65, v66
    v_mov_b32 v66, v68
    v_mov_b32 v67, v70
    v_mov_b32 v68, v72
    v_mov_b32 v69, v74
    v_mov_b32 v70, v76
    v_mov_b32 v71, v78
    v_and_b32 v8, 7, v0
    v_mul_u32_u24 v8, 1040, v8
    v_lshrrev_b32 v9, 3, v0
    v_lshl_add_u32 v8, v9, 5, v8
    v_add_u32 v8, 0, v8
    ds_write_b128 v8, v[64:67]
    ds_write_b128 v8, v[68:71] offset:16
    s_add_u32 s12, s12, 1
    s_branch k3_loop_7
k3_mlp:
    s_lshr_b32 s5, s2, 3
    s_sub_u32 s5, s2, s5
    s_sub_u32 s5, s5, 1
    s_cmp_ge_u32 s5, 128
    s_cbranch_scc1 k3_end
    s_load_dwordx2 s[36:37], s[0:1], 72
    s_load_dwordx2 s[38:39], s[0:1], 88
    s_waitcnt lgkmcnt(0)
    s_mov_b32 s56, s36
    s_and_b32 s57, s37, 0xffff
    s_mov_b32 s58, 2752
    s_mov_b32 s59, 0x00020000
    s_mov_b32 s60, s38
    s_and_b32 s61, s39, 0xffff
    s_mov_b32 s62, 1024
    s_mov_b32 s63, 0x00020000
    s_lshl_b32 s5, s5, 4
    v_add_u32 v5, s5, v4
    v_lshlrev_b32 v5, 10, v5
    v_lshl_add_u32 v5, v3, 4, v5
    v_lshlrev_b32 v6, 4, v2
    buffer_load_dwordx4 v[64:67], v5, s[48:51], 0 offen offset:0
    buffer_load_dwordx4 v[68:71], v5, s[48:51], 0 offen offset:64
    buffer_load_dwordx4 v[72:75], v5, s[48:51], 0 offen offset:128
    buffer_load_dwordx4 v[76:79], v5, s[48:51], 0 offen offset:192
    buffer_load_dwordx4 v[80:83], v5, s[48:51], 0 offen offset:256
    buffer_load_dwordx4 v[84:87], v5, s[48:51], 0 offen offset:320
    buffer_load_dwordx4 v[88:91], v5, s[48:51], 0 offen offset:384
    buffer_load_dwordx4 v[92:95], v5, s[48:51], 0 offen offset:448
    buffer_load_dwordx4 v[96:99], v5, s[48:51], 0 offen offset:512
    buffer_load_dwordx4 v[100:103], v5, s[48:51], 0 offen offset:576
    buffer_load_dwordx4 v[104:107], v5, s[48:51], 0 offen offset:640
    buffer_load_dwordx4 v[108:111], v5, s[48:51], 0 offen offset:704
    buffer_load_dwordx4 v[112:115], v5, s[48:51], 0 offen offset:768
    buffer_load_dwordx4 v[116:119], v5, s[48:51], 0 offen offset:832
    buffer_load_dwordx4 v[120:123], v5, s[48:51], 0 offen offset:896
    buffer_load_dwordx4 v[124:127], v5, s[48:51], 0 offen offset:960
    s_waitcnt vmcnt(0)
    v_mov_b32 v8, 0
    v_xor_b32 v10, 16, v2
    v_lshlrev_b32 v10, 2, v10
    v_xor_b32 v11, 32, v2
    v_lshlrev_b32 v11, 2, v11
    v_lshlrev_b32 v9, 16, v64
    v_add_f32 v8, v8, v9
    v_and_b32 v9, 0xffff0000, v64
    v_add_f32 v8, v8, v9
    v_lshlrev_b32 v9, 16, v65
    v_add_f32 v8, v8, v9
    v_and_b32 v9, 0xffff0000, v65
    v_add_f32 v8, v8, v9
    v_lshlrev_b32 v9, 16, v66
    v_add_f32 v8, v8, v9
    v_and_b32 v9, 0xffff0000, v66
    v_add_f32 v8, v8, v9
    v_lshlrev_b32 v9, 16, v67
    v_add_f32 v8, v8, v9
    v_and_b32 v9, 0xffff0000, v67
    v_add_f32 v8, v8, v9
    v_lshlrev_b32 v9, 16, v68
    v_add_f32 v8, v8, v9
    v_and_b32 v9, 0xffff0000, v68
    v_add_f32 v8, v8, v9
    v_lshlrev_b32 v9, 16, v69
    v_add_f32 v8, v8, v9
    v_and_b32 v9, 0xffff0000, v69
    v_add_f32 v8, v8, v9
    v_lshlrev_b32 v9, 16, v70
    v_add_f32 v8, v8, v9
    v_and_b32 v9, 0xffff0000, v70
    v_add_f32 v8, v8, v9
    v_lshlrev_b32 v9, 16, v71
    v_add_f32 v8, v8, v9
    v_and_b32 v9, 0xffff0000, v71
    v_add_f32 v8, v8, v9
    v_lshlrev_b32 v9, 16, v72
    v_add_f32 v8, v8, v9
    v_and_b32 v9, 0xffff0000, v72
    v_add_f32 v8, v8, v9
    v_lshlrev_b32 v9, 16, v73
    v_add_f32 v8, v8, v9
    v_and_b32 v9, 0xffff0000, v73
    v_add_f32 v8, v8, v9
    v_lshlrev_b32 v9, 16, v74
    v_add_f32 v8, v8, v9
    v_and_b32 v9, 0xffff0000, v74
    v_add_f32 v8, v8, v9
    v_lshlrev_b32 v9, 16, v75
    v_add_f32 v8, v8, v9
    v_and_b32 v9, 0xffff0000, v75
    v_add_f32 v8, v8, v9
    v_lshlrev_b32 v9, 16, v76
    v_add_f32 v8, v8, v9
    v_and_b32 v9, 0xffff0000, v76
    v_add_f32 v8, v8, v9
    v_lshlrev_b32 v9, 16, v77
    v_add_f32 v8, v8, v9
    v_and_b32 v9, 0xffff0000, v77
    v_add_f32 v8, v8, v9
    v_lshlrev_b32 v9, 16, v78
    v_add_f32 v8, v8, v9
    v_and_b32 v9, 0xffff0000, v78
    v_add_f32 v8, v8, v9
    v_lshlrev_b32 v9, 16, v79
    v_add_f32 v8, v8, v9
    v_and_b32 v9, 0xffff0000, v79
    v_add_f32 v8, v8, v9
    v_lshlrev_b32 v9, 16, v80
    v_add_f32 v8, v8, v9
    v_and_b32 v9, 0xffff0000, v80
    v_add_f32 v8, v8, v9
    v_lshlrev_b32 v9, 16, v81
    v_add_f32 v8, v8, v9
    v_and_b32 v9, 0xffff0000, v81
    v_add_f32 v8, v8, v9
    v_lshlrev_b32 v9, 16, v82
    v_add_f32 v8, v8, v9
    v_and_b32 v9, 0xffff0000, v82
    v_add_f32 v8, v8, v9
    v_lshlrev_b32 v9, 16, v83
    v_add_f32 v8, v8, v9
    v_and_b32 v9, 0xffff0000, v83
    v_add_f32 v8, v8, v9
    v_lshlrev_b32 v9, 16, v84
    v_add_f32 v8, v8, v9
    v_and_b32 v9, 0xffff0000, v84
    v_add_f32 v8, v8, v9
    v_lshlrev_b32 v9, 16, v85
    v_add_f32 v8, v8, v9
    v_and_b32 v9, 0xffff0000, v85
    v_add_f32 v8, v8, v9
    v_lshlrev_b32 v9, 16, v86
    v_add_f32 v8, v8, v9
    v_and_b32 v9, 0xffff0000, v86
    v_add_f32 v8, v8, v9
    v_lshlrev_b32 v9, 16, v87
    v_add_f32 v8, v8, v9
    v_and_b32 v9, 0xffff0000, v87
    v_add_f32 v8, v8, v9
    v_lshlrev_b32 v9, 16, v88
    v_add_f32 v8, v8, v9
    v_and_b32 v9, 0xffff0000, v88
    v_add_f32 v8, v8, v9
    v_lshlrev_b32 v9, 16, v89
    v_add_f32 v8, v8, v9
    v_and_b32 v9, 0xffff0000, v89
    v_add_f32 v8, v8, v9
    v_lshlrev_b32 v9, 16, v90
    v_add_f32 v8, v8, v9
    v_and_b32 v9, 0xffff0000, v90
    v_add_f32 v8, v8, v9
    v_lshlrev_b32 v9, 16, v91
    v_add_f32 v8, v8, v9
    v_and_b32 v9, 0xffff0000, v91
    v_add_f32 v8, v8, v9
    v_lshlrev_b32 v9, 16, v92
    v_add_f32 v8, v8, v9
    v_and_b32 v9, 0xffff0000, v92
    v_add_f32 v8, v8, v9
    v_lshlrev_b32 v9, 16, v93
    v_add_f32 v8, v8, v9
    v_and_b32 v9, 0xffff0000, v93
    v_add_f32 v8, v8, v9
    v_lshlrev_b32 v9, 16, v94
    v_add_f32 v8, v8, v9
    v_and_b32 v9, 0xffff0000, v94
    v_add_f32 v8, v8, v9
    v_lshlrev_b32 v9, 16, v95
    v_add_f32 v8, v8, v9
    v_and_b32 v9, 0xffff0000, v95
    v_add_f32 v8, v8, v9
    v_lshlrev_b32 v9, 16, v96
    v_add_f32 v8, v8, v9
    v_and_b32 v9, 0xffff0000, v96
    v_add_f32 v8, v8, v9
    v_lshlrev_b32 v9, 16, v97
    v_add_f32 v8, v8, v9
    v_and_b32 v9, 0xffff0000, v97
    v_add_f32 v8, v8, v9
    v_lshlrev_b32 v9, 16, v98
    v_add_f32 v8, v8, v9
    v_and_b32 v9, 0xffff0000, v98
    v_add_f32 v8, v8, v9
    v_lshlrev_b32 v9, 16, v99
    v_add_f32 v8, v8, v9
    v_and_b32 v9, 0xffff0000, v99
    v_add_f32 v8, v8, v9
    v_lshlrev_b32 v9, 16, v100
    v_add_f32 v8, v8, v9
    v_and_b32 v9, 0xffff0000, v100
    v_add_f32 v8, v8, v9
    v_lshlrev_b32 v9, 16, v101
    v_add_f32 v8, v8, v9
    v_and_b32 v9, 0xffff0000, v101
    v_add_f32 v8, v8, v9
    v_lshlrev_b32 v9, 16, v102
    v_add_f32 v8, v8, v9
    v_and_b32 v9, 0xffff0000, v102
    v_add_f32 v8, v8, v9
    v_lshlrev_b32 v9, 16, v103
    v_add_f32 v8, v8, v9
    v_and_b32 v9, 0xffff0000, v103
    v_add_f32 v8, v8, v9
    v_lshlrev_b32 v9, 16, v104
    v_add_f32 v8, v8, v9
    v_and_b32 v9, 0xffff0000, v104
    v_add_f32 v8, v8, v9
    v_lshlrev_b32 v9, 16, v105
    v_add_f32 v8, v8, v9
    v_and_b32 v9, 0xffff0000, v105
    v_add_f32 v8, v8, v9
    v_lshlrev_b32 v9, 16, v106
    v_add_f32 v8, v8, v9
    v_and_b32 v9, 0xffff0000, v106
    v_add_f32 v8, v8, v9
    v_lshlrev_b32 v9, 16, v107
    v_add_f32 v8, v8, v9
    v_and_b32 v9, 0xffff0000, v107
    v_add_f32 v8, v8, v9
    v_lshlrev_b32 v9, 16, v108
    v_add_f32 v8, v8, v9
    v_and_b32 v9, 0xffff0000, v108
    v_add_f32 v8, v8, v9
    v_lshlrev_b32 v9, 16, v109
    v_add_f32 v8, v8, v9
    v_and_b32 v9, 0xffff0000, v109
    v_add_f32 v8, v8, v9
    v_lshlrev_b32 v9, 16, v110
    v_add_f32 v8, v8, v9
    v_and_b32 v9, 0xffff0000, v110
    v_add_f32 v8, v8, v9
    v_lshlrev_b32 v9, 16, v111
    v_add_f32 v8, v8, v9
    v_and_b32 v9, 0xffff0000, v111
    v_add_f32 v8, v8, v9
    v_lshlrev_b32 v9, 16, v112
    v_add_f32 v8, v8, v9
    v_and_b32 v9, 0xffff0000, v112
    v_add_f32 v8, v8, v9
    v_lshlrev_b32 v9, 16, v113
    v_add_f32 v8, v8, v9
    v_and_b32 v9, 0xffff0000, v113
    v_add_f32 v8, v8, v9
    v_lshlrev_b32 v9, 16, v114
    v_add_f32 v8, v8, v9
    v_and_b32 v9, 0xffff0000, v114
    v_add_f32 v8, v8, v9
    v_lshlrev_b32 v9, 16, v115
    v_add_f32 v8, v8, v9
    v_and_b32 v9, 0xffff0000, v115
    v_add_f32 v8, v8, v9
    v_lshlrev_b32 v9, 16, v116
    v_add_f32 v8, v8, v9
    v_and_b32 v9, 0xffff0000, v116
    v_add_f32 v8, v8, v9
    v_lshlrev_b32 v9, 16, v117
    v_add_f32 v8, v8, v9
    v_and_b32 v9, 0xffff0000, v117
    v_add_f32 v8, v8, v9
    v_lshlrev_b32 v9, 16, v118
    v_add_f32 v8, v8, v9
    v_and_b32 v9, 0xffff0000, v118
    v_add_f32 v8, v8, v9
    v_lshlrev_b32 v9, 16, v119
    v_add_f32 v8, v8, v9
    v_and_b32 v9, 0xffff0000, v119
    v_add_f32 v8, v8, v9
    v_lshlrev_b32 v9, 16, v120
    v_add_f32 v8, v8, v9
    v_and_b32 v9, 0xffff0000, v120
    v_add_f32 v8, v8, v9
    v_lshlrev_b32 v9, 16, v121
    v_add_f32 v8, v8, v9
    v_and_b32 v9, 0xffff0000, v121
    v_add_f32 v8, v8, v9
    v_lshlrev_b32 v9, 16, v122
    v_add_f32 v8, v8, v9
    v_and_b32 v9, 0xffff0000, v122
    v_add_f32 v8, v8, v9
    v_lshlrev_b32 v9, 16, v123
    v_add_f32 v8, v8, v9
    v_and_b32 v9, 0xffff0000, v123
    v_add_f32 v8, v8, v9
    v_lshlrev_b32 v9, 16, v124
    v_add_f32 v8, v8, v9
    v_and_b32 v9, 0xffff0000, v124
    v_add_f32 v8, v8, v9
    v_lshlrev_b32 v9, 16, v125
    v_add_f32 v8, v8, v9
    v_and_b32 v9, 0xffff0000, v125
    v_add_f32 v8, v8, v9
    v_lshlrev_b32 v9, 16, v126
    v_add_f32 v8, v8, v9
    v_and_b32 v9, 0xffff0000, v126
    v_add_f32 v8, v8, v9
    v_lshlrev_b32 v9, 16, v127
    v_add_f32 v8, v8, v9
    v_and_b32 v9, 0xffff0000, v127
    v_add_f32 v8, v8, v9
    ds_bpermute_b32 v12, v10, v8
    s_waitcnt lgkmcnt(0)
    v_add_f32 v8, v8, v12
    ds_bpermute_b32 v12, v11, v8
    s_waitcnt lgkmcnt(0)
    v_add_f32 v8, v8, v12
    v_mul_f32 v8, 0x3b000000, v8
    v_mov_b32 v13, v8
    v_mov_b32 v8, 0
    v_lshlrev_b32 v9, 16, v64
    v_sub_f32 v9, v9, v13
    v_fmac_f32 v8, v9, v9
    v_and_b32 v9, 0xffff0000, v64
    v_sub_f32 v9, v9, v13
    v_fmac_f32 v8, v9, v9
    v_lshlrev_b32 v9, 16, v65
    v_sub_f32 v9, v9, v13
    v_fmac_f32 v8, v9, v9
    v_and_b32 v9, 0xffff0000, v65
    v_sub_f32 v9, v9, v13
    v_fmac_f32 v8, v9, v9
    v_lshlrev_b32 v9, 16, v66
    v_sub_f32 v9, v9, v13
    v_fmac_f32 v8, v9, v9
    v_and_b32 v9, 0xffff0000, v66
    v_sub_f32 v9, v9, v13
    v_fmac_f32 v8, v9, v9
    v_lshlrev_b32 v9, 16, v67
    v_sub_f32 v9, v9, v13
    v_fmac_f32 v8, v9, v9
    v_and_b32 v9, 0xffff0000, v67
    v_sub_f32 v9, v9, v13
    v_fmac_f32 v8, v9, v9
    v_lshlrev_b32 v9, 16, v68
    v_sub_f32 v9, v9, v13
    v_fmac_f32 v8, v9, v9
    v_and_b32 v9, 0xffff0000, v68
    v_sub_f32 v9, v9, v13
    v_fmac_f32 v8, v9, v9
    v_lshlrev_b32 v9, 16, v69
    v_sub_f32 v9, v9, v13
    v_fmac_f32 v8, v9, v9
    v_and_b32 v9, 0xffff0000, v69
    v_sub_f32 v9, v9, v13
    v_fmac_f32 v8, v9, v9
    v_lshlrev_b32 v9, 16, v70
    v_sub_f32 v9, v9, v13
    v_fmac_f32 v8, v9, v9
    v_and_b32 v9, 0xffff0000, v70
    v_sub_f32 v9, v9, v13
    v_fmac_f32 v8, v9, v9
    v_lshlrev_b32 v9, 16, v71
    v_sub_f32 v9, v9, v13
    v_fmac_f32 v8, v9, v9
    v_and_b32 v9, 0xffff0000, v71
    v_sub_f32 v9, v9, v13
    v_fmac_f32 v8, v9, v9
    v_lshlrev_b32 v9, 16, v72
    v_sub_f32 v9, v9, v13
    v_fmac_f32 v8, v9, v9
    v_and_b32 v9, 0xffff0000, v72
    v_sub_f32 v9, v9, v13
    v_fmac_f32 v8, v9, v9
    v_lshlrev_b32 v9, 16, v73
    v_sub_f32 v9, v9, v13
    v_fmac_f32 v8, v9, v9
    v_and_b32 v9, 0xffff0000, v73
    v_sub_f32 v9, v9, v13
    v_fmac_f32 v8, v9, v9
    v_lshlrev_b32 v9, 16, v74
    v_sub_f32 v9, v9, v13
    v_fmac_f32 v8, v9, v9
    v_and_b32 v9, 0xffff0000, v74
    v_sub_f32 v9, v9, v13
    v_fmac_f32 v8, v9, v9
    v_lshlrev_b32 v9, 16, v75
    v_sub_f32 v9, v9, v13
    v_fmac_f32 v8, v9, v9
    v_and_b32 v9, 0xffff0000, v75
    v_sub_f32 v9, v9, v13
    v_fmac_f32 v8, v9, v9
    v_lshlrev_b32 v9, 16, v76
    v_sub_f32 v9, v9, v13
    v_fmac_f32 v8, v9, v9
    v_and_b32 v9, 0xffff0000, v76
    v_sub_f32 v9, v9, v13
    v_fmac_f32 v8, v9, v9
    v_lshlrev_b32 v9, 16, v77
    v_sub_f32 v9, v9, v13
    v_fmac_f32 v8, v9, v9
    v_and_b32 v9, 0xffff0000, v77
    v_sub_f32 v9, v9, v13
    v_fmac_f32 v8, v9, v9
    v_lshlrev_b32 v9, 16, v78
    v_sub_f32 v9, v9, v13
    v_fmac_f32 v8, v9, v9
    v_and_b32 v9, 0xffff0000, v78
    v_sub_f32 v9, v9, v13
    v_fmac_f32 v8, v9, v9
    v_lshlrev_b32 v9, 16, v79
    v_sub_f32 v9, v9, v13
    v_fmac_f32 v8, v9, v9
    v_and_b32 v9, 0xffff0000, v79
    v_sub_f32 v9, v9, v13
    v_fmac_f32 v8, v9, v9
    v_lshlrev_b32 v9, 16, v80
    v_sub_f32 v9, v9, v13
    v_fmac_f32 v8, v9, v9
    v_and_b32 v9, 0xffff0000, v80
    v_sub_f32 v9, v9, v13
    v_fmac_f32 v8, v9, v9
    v_lshlrev_b32 v9, 16, v81
    v_sub_f32 v9, v9, v13
    v_fmac_f32 v8, v9, v9
    v_and_b32 v9, 0xffff0000, v81
    v_sub_f32 v9, v9, v13
    v_fmac_f32 v8, v9, v9
    v_lshlrev_b32 v9, 16, v82
    v_sub_f32 v9, v9, v13
    v_fmac_f32 v8, v9, v9
    v_and_b32 v9, 0xffff0000, v82
    v_sub_f32 v9, v9, v13
    v_fmac_f32 v8, v9, v9
    v_lshlrev_b32 v9, 16, v83
    v_sub_f32 v9, v9, v13
    v_fmac_f32 v8, v9, v9
    v_and_b32 v9, 0xffff0000, v83
    v_sub_f32 v9, v9, v13
    v_fmac_f32 v8, v9, v9
    v_lshlrev_b32 v9, 16, v84
    v_sub_f32 v9, v9, v13
    v_fmac_f32 v8, v9, v9
    v_and_b32 v9, 0xffff0000, v84
    v_sub_f32 v9, v9, v13
    v_fmac_f32 v8, v9, v9
    v_lshlrev_b32 v9, 16, v85
    v_sub_f32 v9, v9, v13
    v_fmac_f32 v8, v9, v9
    v_and_b32 v9, 0xffff0000, v85
    v_sub_f32 v9, v9, v13
    v_fmac_f32 v8, v9, v9
    v_lshlrev_b32 v9, 16, v86
    v_sub_f32 v9, v9, v13
    v_fmac_f32 v8, v9, v9
    v_and_b32 v9, 0xffff0000, v86
    v_sub_f32 v9, v9, v13
    v_fmac_f32 v8, v9, v9
    v_lshlrev_b32 v9, 16, v87
    v_sub_f32 v9, v9, v13
    v_fmac_f32 v8, v9, v9
    v_and_b32 v9, 0xffff0000, v87
    v_sub_f32 v9, v9, v13
    v_fmac_f32 v8, v9, v9
    v_lshlrev_b32 v9, 16, v88
    v_sub_f32 v9, v9, v13
    v_fmac_f32 v8, v9, v9
    v_and_b32 v9, 0xffff0000, v88
    v_sub_f32 v9, v9, v13
    v_fmac_f32 v8, v9, v9
    v_lshlrev_b32 v9, 16, v89
    v_sub_f32 v9, v9, v13
    v_fmac_f32 v8, v9, v9
    v_and_b32 v9, 0xffff0000, v89
    v_sub_f32 v9, v9, v13
    v_fmac_f32 v8, v9, v9
    v_lshlrev_b32 v9, 16, v90
    v_sub_f32 v9, v9, v13
    v_fmac_f32 v8, v9, v9
    v_and_b32 v9, 0xffff0000, v90
    v_sub_f32 v9, v9, v13
    v_fmac_f32 v8, v9, v9
    v_lshlrev_b32 v9, 16, v91
    v_sub_f32 v9, v9, v13
    v_fmac_f32 v8, v9, v9
    v_and_b32 v9, 0xffff0000, v91
    v_sub_f32 v9, v9, v13
    v_fmac_f32 v8, v9, v9
    v_lshlrev_b32 v9, 16, v92
    v_sub_f32 v9, v9, v13
    v_fmac_f32 v8, v9, v9
    v_and_b32 v9, 0xffff0000, v92
    v_sub_f32 v9, v9, v13
    v_fmac_f32 v8, v9, v9
    v_lshlrev_b32 v9, 16, v93
    v_sub_f32 v9, v9, v13
    v_fmac_f32 v8, v9, v9
    v_and_b32 v9, 0xffff0000, v93
    v_sub_f32 v9, v9, v13
    v_fmac_f32 v8, v9, v9
    v_lshlrev_b32 v9, 16, v94
    v_sub_f32 v9, v9, v13
    v_fmac_f32 v8, v9, v9
    v_and_b32 v9, 0xffff0000, v94
    v_sub_f32 v9, v9, v13
    v_fmac_f32 v8, v9, v9
    v_lshlrev_b32 v9, 16, v95
    v_sub_f32 v9, v9, v13
    v_fmac_f32 v8, v9, v9
    v_and_b32 v9, 0xffff0000, v95
    v_sub_f32 v9, v9, v13
    v_fmac_f32 v8, v9, v9
    v_lshlrev_b32 v9, 16, v96
    v_sub_f32 v9, v9, v13
    v_fmac_f32 v8, v9, v9
    v_and_b32 v9, 0xffff0000, v96
    v_sub_f32 v9, v9, v13
    v_fmac_f32 v8, v9, v9
    v_lshlrev_b32 v9, 16, v97
    v_sub_f32 v9, v9, v13
    v_fmac_f32 v8, v9, v9
    v_and_b32 v9, 0xffff0000, v97
    v_sub_f32 v9, v9, v13
    v_fmac_f32 v8, v9, v9
    v_lshlrev_b32 v9, 16, v98
    v_sub_f32 v9, v9, v13
    v_fmac_f32 v8, v9, v9
    v_and_b32 v9, 0xffff0000, v98
    v_sub_f32 v9, v9, v13
    v_fmac_f32 v8, v9, v9
    v_lshlrev_b32 v9, 16, v99
    v_sub_f32 v9, v9, v13
    v_fmac_f32 v8, v9, v9
    v_and_b32 v9, 0xffff0000, v99
    v_sub_f32 v9, v9, v13
    v_fmac_f32 v8, v9, v9
    v_lshlrev_b32 v9, 16, v100
    v_sub_f32 v9, v9, v13
    v_fmac_f32 v8, v9, v9
    v_and_b32 v9, 0xffff0000, v100
    v_sub_f32 v9, v9, v13
    v_fmac_f32 v8, v9, v9
    v_lshlrev_b32 v9, 16, v101
    v_sub_f32 v9, v9, v13
    v_fmac_f32 v8, v9, v9
    v_and_b32 v9, 0xffff0000, v101
    v_sub_f32 v9, v9, v13
    v_fmac_f32 v8, v9, v9
    v_lshlrev_b32 v9, 16, v102
    v_sub_f32 v9, v9, v13
    v_fmac_f32 v8, v9, v9
    v_and_b32 v9, 0xffff0000, v102
    v_sub_f32 v9, v9, v13
    v_fmac_f32 v8, v9, v9
    v_lshlrev_b32 v9, 16, v103
    v_sub_f32 v9, v9, v13
    v_fmac_f32 v8, v9, v9
    v_and_b32 v9, 0xffff0000, v103
    v_sub_f32 v9, v9, v13
    v_fmac_f32 v8, v9, v9
    v_lshlrev_b32 v9, 16, v104
    v_sub_f32 v9, v9, v13
    v_fmac_f32 v8, v9, v9
    v_and_b32 v9, 0xffff0000, v104
    v_sub_f32 v9, v9, v13
    v_fmac_f32 v8, v9, v9
    v_lshlrev_b32 v9, 16, v105
    v_sub_f32 v9, v9, v13
    v_fmac_f32 v8, v9, v9
    v_and_b32 v9, 0xffff0000, v105
    v_sub_f32 v9, v9, v13
    v_fmac_f32 v8, v9, v9
    v_lshlrev_b32 v9, 16, v106
    v_sub_f32 v9, v9, v13
    v_fmac_f32 v8, v9, v9
    v_and_b32 v9, 0xffff0000, v106
    v_sub_f32 v9, v9, v13
    v_fmac_f32 v8, v9, v9
    v_lshlrev_b32 v9, 16, v107
    v_sub_f32 v9, v9, v13
    v_fmac_f32 v8, v9, v9
    v_and_b32 v9, 0xffff0000, v107
    v_sub_f32 v9, v9, v13
    v_fmac_f32 v8, v9, v9
    v_lshlrev_b32 v9, 16, v108
    v_sub_f32 v9, v9, v13
    v_fmac_f32 v8, v9, v9
    v_and_b32 v9, 0xffff0000, v108
    v_sub_f32 v9, v9, v13
    v_fmac_f32 v8, v9, v9
    v_lshlrev_b32 v9, 16, v109
    v_sub_f32 v9, v9, v13
    v_fmac_f32 v8, v9, v9
    v_and_b32 v9, 0xffff0000, v109
    v_sub_f32 v9, v9, v13
    v_fmac_f32 v8, v9, v9
    v_lshlrev_b32 v9, 16, v110
    v_sub_f32 v9, v9, v13
    v_fmac_f32 v8, v9, v9
    v_and_b32 v9, 0xffff0000, v110
    v_sub_f32 v9, v9, v13
    v_fmac_f32 v8, v9, v9
    v_lshlrev_b32 v9, 16, v111
    v_sub_f32 v9, v9, v13
    v_fmac_f32 v8, v9, v9
    v_and_b32 v9, 0xffff0000, v111
    v_sub_f32 v9, v9, v13
    v_fmac_f32 v8, v9, v9
    v_lshlrev_b32 v9, 16, v112
    v_sub_f32 v9, v9, v13
    v_fmac_f32 v8, v9, v9
    v_and_b32 v9, 0xffff0000, v112
    v_sub_f32 v9, v9, v13
    v_fmac_f32 v8, v9, v9
    v_lshlrev_b32 v9, 16, v113
    v_sub_f32 v9, v9, v13
    v_fmac_f32 v8, v9, v9
    v_and_b32 v9, 0xffff0000, v113
    v_sub_f32 v9, v9, v13
    v_fmac_f32 v8, v9, v9
    v_lshlrev_b32 v9, 16, v114
    v_sub_f32 v9, v9, v13
    v_fmac_f32 v8, v9, v9
    v_and_b32 v9, 0xffff0000, v114
    v_sub_f32 v9, v9, v13
    v_fmac_f32 v8, v9, v9
    v_lshlrev_b32 v9, 16, v115
    v_sub_f32 v9, v9, v13
    v_fmac_f32 v8, v9, v9
    v_and_b32 v9, 0xffff0000, v115
    v_sub_f32 v9, v9, v13
    v_fmac_f32 v8, v9, v9
    v_lshlrev_b32 v9, 16, v116
    v_sub_f32 v9, v9, v13
    v_fmac_f32 v8, v9, v9
    v_and_b32 v9, 0xffff0000, v116
    v_sub_f32 v9, v9, v13
    v_fmac_f32 v8, v9, v9
    v_lshlrev_b32 v9, 16, v117
    v_sub_f32 v9, v9, v13
    v_fmac_f32 v8, v9, v9
    v_and_b32 v9, 0xffff0000, v117
    v_sub_f32 v9, v9, v13
    v_fmac_f32 v8, v9, v9
    v_lshlrev_b32 v9, 16, v118
    v_sub_f32 v9, v9, v13
    v_fmac_f32 v8, v9, v9
    v_and_b32 v9, 0xffff0000, v118
    v_sub_f32 v9, v9, v13
    v_fmac_f32 v8, v9, v9
    v_lshlrev_b32 v9, 16, v119
    v_sub_f32 v9, v9, v13
    v_fmac_f32 v8, v9, v9
    v_and_b32 v9, 0xffff0000, v119
    v_sub_f32 v9, v9, v13
    v_fmac_f32 v8, v9, v9
    v_lshlrev_b32 v9, 16, v120
    v_sub_f32 v9, v9, v13
    v_fmac_f32 v8, v9, v9
    v_and_b32 v9, 0xffff0000, v120
    v_sub_f32 v9, v9, v13
    v_fmac_f32 v8, v9, v9
    v_lshlrev_b32 v9, 16, v121
    v_sub_f32 v9, v9, v13
    v_fmac_f32 v8, v9, v9
    v_and_b32 v9, 0xffff0000, v121
    v_sub_f32 v9, v9, v13
    v_fmac_f32 v8, v9, v9
    v_lshlrev_b32 v9, 16, v122
    v_sub_f32 v9, v9, v13
    v_fmac_f32 v8, v9, v9
    v_and_b32 v9, 0xffff0000, v122
    v_sub_f32 v9, v9, v13
    v_fmac_f32 v8, v9, v9
    v_lshlrev_b32 v9, 16, v123
    v_sub_f32 v9, v9, v13
    v_fmac_f32 v8, v9, v9
    v_and_b32 v9, 0xffff0000, v123
    v_sub_f32 v9, v9, v13
    v_fmac_f32 v8, v9, v9
    v_lshlrev_b32 v9, 16, v124
    v_sub_f32 v9, v9, v13
    v_fmac_f32 v8, v9, v9
    v_and_b32 v9, 0xffff0000, v124
    v_sub_f32 v9, v9, v13
    v_fmac_f32 v8, v9, v9
    v_lshlrev_b32 v9, 16, v125
    v_sub_f32 v9, v9, v13
    v_fmac_f32 v8, v9, v9
    v_and_b32 v9, 0xffff0000, v125
    v_sub_f32 v9, v9, v13
    v_fmac_f32 v8, v9, v9
    v_lshlrev_b32 v9, 16, v126
    v_sub_f32 v9, v9, v13
    v_fmac_f32 v8, v9, v9
    v_and_b32 v9, 0xffff0000, v126
    v_sub_f32 v9, v9, v13
    v_fmac_f32 v8, v9, v9
    v_lshlrev_b32 v9, 16, v127
    v_sub_f32 v9, v9, v13
    v_fmac_f32 v8, v9, v9
    v_and_b32 v9, 0xffff0000, v127
    v_sub_f32 v9, v9, v13
    v_fmac_f32 v8, v9, v9
    ds_bpermute_b32 v12, v10, v8
    s_waitcnt lgkmcnt(0)
    v_add_f32 v8, v8, v12
    ds_bpermute_b32 v12, v11, v8
    s_waitcnt lgkmcnt(0)
    v_add_f32 v8, v8, v12
    v_mul_f32 v8, 0x3b000000, v8
    v_add_f32 v8, 0x3727c5ac, v8
    v_sqrt_f32 v8, v8
    s_nop 0
    v_rcp_f32 v8, v8
    s_nop 0
    v_lshlrev_b32 v9, 16, v64
    v_sub_f32 v9, v9, v13
    v_mul_f32 v9, v9, v8
    v_and_b32 v12, 0xffff0000, v64
    v_sub_f32 v12, v12, v13
    v_mul_f32 v12, v12, v8
    v_cvt_pk_bf16_f32 v64, v9, v12
    v_lshlrev_b32 v9, 16, v65
    v_sub_f32 v9, v9, v13
    v_mul_f32 v9, v9, v8
    v_and_b32 v12, 0xffff0000, v65
    v_sub_f32 v12, v12, v13
    v_mul_f32 v12, v12, v8
    v_cvt_pk_bf16_f32 v65, v9, v12
    v_lshlrev_b32 v9, 16, v66
    v_sub_f32 v9, v9, v13
    v_mul_f32 v9, v9, v8
    v_and_b32 v12, 0xffff0000, v66
    v_sub_f32 v12, v12, v13
    v_mul_f32 v12, v12, v8
    v_cvt_pk_bf16_f32 v66, v9, v12
    v_lshlrev_b32 v9, 16, v67
    v_sub_f32 v9, v9, v13
    v_mul_f32 v9, v9, v8
    v_and_b32 v12, 0xffff0000, v67
    v_sub_f32 v12, v12, v13
    v_mul_f32 v12, v12, v8
    v_cvt_pk_bf16_f32 v67, v9, v12
    v_lshlrev_b32 v9, 16, v68
    v_sub_f32 v9, v9, v13
    v_mul_f32 v9, v9, v8
    v_and_b32 v12, 0xffff0000, v68
    v_sub_f32 v12, v12, v13
    v_mul_f32 v12, v12, v8
    v_cvt_pk_bf16_f32 v68, v9, v12
    v_lshlrev_b32 v9, 16, v69
    v_sub_f32 v9, v9, v13
    v_mul_f32 v9, v9, v8
    v_and_b32 v12, 0xffff0000, v69
    v_sub_f32 v12, v12, v13
    v_mul_f32 v12, v12, v8
    v_cvt_pk_bf16_f32 v69, v9, v12
    v_lshlrev_b32 v9, 16, v70
    v_sub_f32 v9, v9, v13
    v_mul_f32 v9, v9, v8
    v_and_b32 v12, 0xffff0000, v70
    v_sub_f32 v12, v12, v13
    v_mul_f32 v12, v12, v8
    v_cvt_pk_bf16_f32 v70, v9, v12
    v_lshlrev_b32 v9, 16, v71
    v_sub_f32 v9, v9, v13
    v_mul_f32 v9, v9, v8
    v_and_b32 v12, 0xffff0000, v71
    v_sub_f32 v12, v12, v13
    v_mul_f32 v12, v12, v8
    v_cvt_pk_bf16_f32 v71, v9, v12
    v_lshlrev_b32 v9, 16, v72
    v_sub_f32 v9, v9, v13
    v_mul_f32 v9, v9, v8
    v_and_b32 v12, 0xffff0000, v72
    v_sub_f32 v12, v12, v13
    v_mul_f32 v12, v12, v8
    v_cvt_pk_bf16_f32 v72, v9, v12
    v_lshlrev_b32 v9, 16, v73
    v_sub_f32 v9, v9, v13
    v_mul_f32 v9, v9, v8
    v_and_b32 v12, 0xffff0000, v73
    v_sub_f32 v12, v12, v13
    v_mul_f32 v12, v12, v8
    v_cvt_pk_bf16_f32 v73, v9, v12
    v_lshlrev_b32 v9, 16, v74
    v_sub_f32 v9, v9, v13
    v_mul_f32 v9, v9, v8
    v_and_b32 v12, 0xffff0000, v74
    v_sub_f32 v12, v12, v13
    v_mul_f32 v12, v12, v8
    v_cvt_pk_bf16_f32 v74, v9, v12
    v_lshlrev_b32 v9, 16, v75
    v_sub_f32 v9, v9, v13
    v_mul_f32 v9, v9, v8
    v_and_b32 v12, 0xffff0000, v75
    v_sub_f32 v12, v12, v13
    v_mul_f32 v12, v12, v8
    v_cvt_pk_bf16_f32 v75, v9, v12
    v_lshlrev_b32 v9, 16, v76
    v_sub_f32 v9, v9, v13
    v_mul_f32 v9, v9, v8
    v_and_b32 v12, 0xffff0000, v76
    v_sub_f32 v12, v12, v13
    v_mul_f32 v12, v12, v8
    v_cvt_pk_bf16_f32 v76, v9, v12
    v_lshlrev_b32 v9, 16, v77
    v_sub_f32 v9, v9, v13
    v_mul_f32 v9, v9, v8
    v_and_b32 v12, 0xffff0000, v77
    v_sub_f32 v12, v12, v13
    v_mul_f32 v12, v12, v8
    v_cvt_pk_bf16_f32 v77, v9, v12
    v_lshlrev_b32 v9, 16, v78
    v_sub_f32 v9, v9, v13
    v_mul_f32 v9, v9, v8
    v_and_b32 v12, 0xffff0000, v78
    v_sub_f32 v12, v12, v13
    v_mul_f32 v12, v12, v8
    v_cvt_pk_bf16_f32 v78, v9, v12
    v_lshlrev_b32 v9, 16, v79
    v_sub_f32 v9, v9, v13
    v_mul_f32 v9, v9, v8
    v_and_b32 v12, 0xffff0000, v79
    v_sub_f32 v12, v12, v13
    v_mul_f32 v12, v12, v8
    v_cvt_pk_bf16_f32 v79, v9, v12
    v_lshlrev_b32 v9, 16, v80
    v_sub_f32 v9, v9, v13
    v_mul_f32 v9, v9, v8
    v_and_b32 v12, 0xffff0000, v80
    v_sub_f32 v12, v12, v13
    v_mul_f32 v12, v12, v8
    v_cvt_pk_bf16_f32 v80, v9, v12
    v_lshlrev_b32 v9, 16, v81
    v_sub_f32 v9, v9, v13
    v_mul_f32 v9, v9, v8
    v_and_b32 v12, 0xffff0000, v81
    v_sub_f32 v12, v12, v13
    v_mul_f32 v12, v12, v8
    v_cvt_pk_bf16_f32 v81, v9, v12
    v_lshlrev_b32 v9, 16, v82
    v_sub_f32 v9, v9, v13
    v_mul_f32 v9, v9, v8
    v_and_b32 v12, 0xffff0000, v82
    v_sub_f32 v12, v12, v13
    v_mul_f32 v12, v12, v8
    v_cvt_pk_bf16_f32 v82, v9, v12
    v_lshlrev_b32 v9, 16, v83
    v_sub_f32 v9, v9, v13
    v_mul_f32 v9, v9, v8
    v_and_b32 v12, 0xffff0000, v83
    v_sub_f32 v12, v12, v13
    v_mul_f32 v12, v12, v8
    v_cvt_pk_bf16_f32 v83, v9, v12
    v_lshlrev_b32 v9, 16, v84
    v_sub_f32 v9, v9, v13
    v_mul_f32 v9, v9, v8
    v_and_b32 v12, 0xffff0000, v84
    v_sub_f32 v12, v12, v13
    v_mul_f32 v12, v12, v8
    v_cvt_pk_bf16_f32 v84, v9, v12
    v_lshlrev_b32 v9, 16, v85
    v_sub_f32 v9, v9, v13
    v_mul_f32 v9, v9, v8
    v_and_b32 v12, 0xffff0000, v85
    v_sub_f32 v12, v12, v13
    v_mul_f32 v12, v12, v8
    v_cvt_pk_bf16_f32 v85, v9, v12
    v_lshlrev_b32 v9, 16, v86
    v_sub_f32 v9, v9, v13
    v_mul_f32 v9, v9, v8
    v_and_b32 v12, 0xffff0000, v86
    v_sub_f32 v12, v12, v13
    v_mul_f32 v12, v12, v8
    v_cvt_pk_bf16_f32 v86, v9, v12
    v_lshlrev_b32 v9, 16, v87
    v_sub_f32 v9, v9, v13
    v_mul_f32 v9, v9, v8
    v_and_b32 v12, 0xffff0000, v87
    v_sub_f32 v12, v12, v13
    v_mul_f32 v12, v12, v8
    v_cvt_pk_bf16_f32 v87, v9, v12
    v_lshlrev_b32 v9, 16, v88
    v_sub_f32 v9, v9, v13
    v_mul_f32 v9, v9, v8
    v_and_b32 v12, 0xffff0000, v88
    v_sub_f32 v12, v12, v13
    v_mul_f32 v12, v12, v8
    v_cvt_pk_bf16_f32 v88, v9, v12
    v_lshlrev_b32 v9, 16, v89
    v_sub_f32 v9, v9, v13
    v_mul_f32 v9, v9, v8
    v_and_b32 v12, 0xffff0000, v89
    v_sub_f32 v12, v12, v13
    v_mul_f32 v12, v12, v8
    v_cvt_pk_bf16_f32 v89, v9, v12
    v_lshlrev_b32 v9, 16, v90
    v_sub_f32 v9, v9, v13
    v_mul_f32 v9, v9, v8
    v_and_b32 v12, 0xffff0000, v90
    v_sub_f32 v12, v12, v13
    v_mul_f32 v12, v12, v8
    v_cvt_pk_bf16_f32 v90, v9, v12
    v_lshlrev_b32 v9, 16, v91
    v_sub_f32 v9, v9, v13
    v_mul_f32 v9, v9, v8
    v_and_b32 v12, 0xffff0000, v91
    v_sub_f32 v12, v12, v13
    v_mul_f32 v12, v12, v8
    v_cvt_pk_bf16_f32 v91, v9, v12
    v_lshlrev_b32 v9, 16, v92
    v_sub_f32 v9, v9, v13
    v_mul_f32 v9, v9, v8
    v_and_b32 v12, 0xffff0000, v92
    v_sub_f32 v12, v12, v13
    v_mul_f32 v12, v12, v8
    v_cvt_pk_bf16_f32 v92, v9, v12
    v_lshlrev_b32 v9, 16, v93
    v_sub_f32 v9, v9, v13
    v_mul_f32 v9, v9, v8
    v_and_b32 v12, 0xffff0000, v93
    v_sub_f32 v12, v12, v13
    v_mul_f32 v12, v12, v8
    v_cvt_pk_bf16_f32 v93, v9, v12
    v_lshlrev_b32 v9, 16, v94
    v_sub_f32 v9, v9, v13
    v_mul_f32 v9, v9, v8
    v_and_b32 v12, 0xffff0000, v94
    v_sub_f32 v12, v12, v13
    v_mul_f32 v12, v12, v8
    v_cvt_pk_bf16_f32 v94, v9, v12
    v_lshlrev_b32 v9, 16, v95
    v_sub_f32 v9, v9, v13
    v_mul_f32 v9, v9, v8
    v_and_b32 v12, 0xffff0000, v95
    v_sub_f32 v12, v12, v13
    v_mul_f32 v12, v12, v8
    v_cvt_pk_bf16_f32 v95, v9, v12
    v_lshlrev_b32 v9, 16, v96
    v_sub_f32 v9, v9, v13
    v_mul_f32 v9, v9, v8
    v_and_b32 v12, 0xffff0000, v96
    v_sub_f32 v12, v12, v13
    v_mul_f32 v12, v12, v8
    v_cvt_pk_bf16_f32 v96, v9, v12
    v_lshlrev_b32 v9, 16, v97
    v_sub_f32 v9, v9, v13
    v_mul_f32 v9, v9, v8
    v_and_b32 v12, 0xffff0000, v97
    v_sub_f32 v12, v12, v13
    v_mul_f32 v12, v12, v8
    v_cvt_pk_bf16_f32 v97, v9, v12
    v_lshlrev_b32 v9, 16, v98
    v_sub_f32 v9, v9, v13
    v_mul_f32 v9, v9, v8
    v_and_b32 v12, 0xffff0000, v98
    v_sub_f32 v12, v12, v13
    v_mul_f32 v12, v12, v8
    v_cvt_pk_bf16_f32 v98, v9, v12
    v_lshlrev_b32 v9, 16, v99
    v_sub_f32 v9, v9, v13
    v_mul_f32 v9, v9, v8
    v_and_b32 v12, 0xffff0000, v99
    v_sub_f32 v12, v12, v13
    v_mul_f32 v12, v12, v8
    v_cvt_pk_bf16_f32 v99, v9, v12
    v_lshlrev_b32 v9, 16, v100
    v_sub_f32 v9, v9, v13
    v_mul_f32 v9, v9, v8
    v_and_b32 v12, 0xffff0000, v100
    v_sub_f32 v12, v12, v13
    v_mul_f32 v12, v12, v8
    v_cvt_pk_bf16_f32 v100, v9, v12
    v_lshlrev_b32 v9, 16, v101
    v_sub_f32 v9, v9, v13
    v_mul_f32 v9, v9, v8
    v_and_b32 v12, 0xffff0000, v101
    v_sub_f32 v12, v12, v13
    v_mul_f32 v12, v12, v8
    v_cvt_pk_bf16_f32 v101, v9, v12
    v_lshlrev_b32 v9, 16, v102
    v_sub_f32 v9, v9, v13
    v_mul_f32 v9, v9, v8
    v_and_b32 v12, 0xffff0000, v102
    v_sub_f32 v12, v12, v13
    v_mul_f32 v12, v12, v8
    v_cvt_pk_bf16_f32 v102, v9, v12
    v_lshlrev_b32 v9, 16, v103
    v_sub_f32 v9, v9, v13
    v_mul_f32 v9, v9, v8
    v_and_b32 v12, 0xffff0000, v103
    v_sub_f32 v12, v12, v13
    v_mul_f32 v12, v12, v8
    v_cvt_pk_bf16_f32 v103, v9, v12
    v_lshlrev_b32 v9, 16, v104
    v_sub_f32 v9, v9, v13
    v_mul_f32 v9, v9, v8
    v_and_b32 v12, 0xffff0000, v104
    v_sub_f32 v12, v12, v13
    v_mul_f32 v12, v12, v8
    v_cvt_pk_bf16_f32 v104, v9, v12
    v_lshlrev_b32 v9, 16, v105
    v_sub_f32 v9, v9, v13
    v_mul_f32 v9, v9, v8
    v_and_b32 v12, 0xffff0000, v105
    v_sub_f32 v12, v12, v13
    v_mul_f32 v12, v12, v8
    v_cvt_pk_bf16_f32 v105, v9, v12
    v_lshlrev_b32 v9, 16, v106
    v_sub_f32 v9, v9, v13
    v_mul_f32 v9, v9, v8
    v_and_b32 v12, 0xffff0000, v106
    v_sub_f32 v12, v12, v13
    v_mul_f32 v12, v12, v8
    v_cvt_pk_bf16_f32 v106, v9, v12
    v_lshlrev_b32 v9, 16, v107
    v_sub_f32 v9, v9, v13
    v_mul_f32 v9, v9, v8
    v_and_b32 v12, 0xffff0000, v107
    v_sub_f32 v12, v12, v13
    v_mul_f32 v12, v12, v8
    v_cvt_pk_bf16_f32 v107, v9, v12
    v_lshlrev_b32 v9, 16, v108
    v_sub_f32 v9, v9, v13
    v_mul_f32 v9, v9, v8
    v_and_b32 v12, 0xffff0000, v108
    v_sub_f32 v12, v12, v13
    v_mul_f32 v12, v12, v8
    v_cvt_pk_bf16_f32 v108, v9, v12
    v_lshlrev_b32 v9, 16, v109
    v_sub_f32 v9, v9, v13
    v_mul_f32 v9, v9, v8
    v_and_b32 v12, 0xffff0000, v109
    v_sub_f32 v12, v12, v13
    v_mul_f32 v12, v12, v8
    v_cvt_pk_bf16_f32 v109, v9, v12
    v_lshlrev_b32 v9, 16, v110
    v_sub_f32 v9, v9, v13
    v_mul_f32 v9, v9, v8
    v_and_b32 v12, 0xffff0000, v110
    v_sub_f32 v12, v12, v13
    v_mul_f32 v12, v12, v8
    v_cvt_pk_bf16_f32 v110, v9, v12
    v_lshlrev_b32 v9, 16, v111
    v_sub_f32 v9, v9, v13
    v_mul_f32 v9, v9, v8
    v_and_b32 v12, 0xffff0000, v111
    v_sub_f32 v12, v12, v13
    v_mul_f32 v12, v12, v8
    v_cvt_pk_bf16_f32 v111, v9, v12
    v_lshlrev_b32 v9, 16, v112
    v_sub_f32 v9, v9, v13
    v_mul_f32 v9, v9, v8
    v_and_b32 v12, 0xffff0000, v112
    v_sub_f32 v12, v12, v13
    v_mul_f32 v12, v12, v8
    v_cvt_pk_bf16_f32 v112, v9, v12
    v_lshlrev_b32 v9, 16, v113
    v_sub_f32 v9, v9, v13
    v_mul_f32 v9, v9, v8
    v_and_b32 v12, 0xffff0000, v113
    v_sub_f32 v12, v12, v13
    v_mul_f32 v12, v12, v8
    v_cvt_pk_bf16_f32 v113, v9, v12
    v_lshlrev_b32 v9, 16, v114
    v_sub_f32 v9, v9, v13
    v_mul_f32 v9, v9, v8
    v_and_b32 v12, 0xffff0000, v114
    v_sub_f32 v12, v12, v13
    v_mul_f32 v12, v12, v8
    v_cvt_pk_bf16_f32 v114, v9, v12
    v_lshlrev_b32 v9, 16, v115
    v_sub_f32 v9, v9, v13
    v_mul_f32 v9, v9, v8
    v_and_b32 v12, 0xffff0000, v115
    v_sub_f32 v12, v12, v13
    v_mul_f32 v12, v12, v8
    v_cvt_pk_bf16_f32 v115, v9, v12
    v_lshlrev_b32 v9, 16, v116
    v_sub_f32 v9, v9, v13
    v_mul_f32 v9, v9, v8
    v_and_b32 v12, 0xffff0000, v116
    v_sub_f32 v12, v12, v13
    v_mul_f32 v12, v12, v8
    v_cvt_pk_bf16_f32 v116, v9, v12
    v_lshlrev_b32 v9, 16, v117
    v_sub_f32 v9, v9, v13
    v_mul_f32 v9, v9, v8
    v_and_b32 v12, 0xffff0000, v117
    v_sub_f32 v12, v12, v13
    v_mul_f32 v12, v12, v8
    v_cvt_pk_bf16_f32 v117, v9, v12
    v_lshlrev_b32 v9, 16, v118
    v_sub_f32 v9, v9, v13
    v_mul_f32 v9, v9, v8
    v_and_b32 v12, 0xffff0000, v118
    v_sub_f32 v12, v12, v13
    v_mul_f32 v12, v12, v8
    v_cvt_pk_bf16_f32 v118, v9, v12
    v_lshlrev_b32 v9, 16, v119
    v_sub_f32 v9, v9, v13
    v_mul_f32 v9, v9, v8
    v_and_b32 v12, 0xffff0000, v119
    v_sub_f32 v12, v12, v13
    v_mul_f32 v12, v12, v8
    v_cvt_pk_bf16_f32 v119, v9, v12
    v_lshlrev_b32 v9, 16, v120
    v_sub_f32 v9, v9, v13
    v_mul_f32 v9, v9, v8
    v_and_b32 v12, 0xffff0000, v120
    v_sub_f32 v12, v12, v13
    v_mul_f32 v12, v12, v8
    v_cvt_pk_bf16_f32 v120, v9, v12
    v_lshlrev_b32 v9, 16, v121
    v_sub_f32 v9, v9, v13
    v_mul_f32 v9, v9, v8
    v_and_b32 v12, 0xffff0000, v121
    v_sub_f32 v12, v12, v13
    v_mul_f32 v12, v12, v8
    v_cvt_pk_bf16_f32 v121, v9, v12
    v_lshlrev_b32 v9, 16, v122
    v_sub_f32 v9, v9, v13
    v_mul_f32 v9, v9, v8
    v_and_b32 v12, 0xffff0000, v122
    v_sub_f32 v12, v12, v13
    v_mul_f32 v12, v12, v8
    v_cvt_pk_bf16_f32 v122, v9, v12
    v_lshlrev_b32 v9, 16, v123
    v_sub_f32 v9, v9, v13
    v_mul_f32 v9, v9, v8
    v_and_b32 v12, 0xffff0000, v123
    v_sub_f32 v12, v12, v13
    v_mul_f32 v12, v12, v8
    v_cvt_pk_bf16_f32 v123, v9, v12
    v_lshlrev_b32 v9, 16, v124
    v_sub_f32 v9, v9, v13
    v_mul_f32 v9, v9, v8
    v_and_b32 v12, 0xffff0000, v124
    v_sub_f32 v12, v12, v13
    v_mul_f32 v12, v12, v8
    v_cvt_pk_bf16_f32 v124, v9, v12
    v_lshlrev_b32 v9, 16, v125
    v_sub_f32 v9, v9, v13
    v_mul_f32 v9, v9, v8
    v_and_b32 v12, 0xffff0000, v125
    v_sub_f32 v12, v12, v13
    v_mul_f32 v12, v12, v8
    v_cvt_pk_bf16_f32 v125, v9, v12
    v_lshlrev_b32 v9, 16, v126
    v_sub_f32 v9, v9, v13
    v_mul_f32 v9, v9, v8
    v_and_b32 v12, 0xffff0000, v126
    v_sub_f32 v12, v12, v13
    v_mul_f32 v12, v12, v8
    v_cvt_pk_bf16_f32 v126, v9, v12
    v_lshlrev_b32 v9, 16, v127
    v_sub_f32 v9, v9, v13
    v_mul_f32 v9, v9, v8
    v_and_b32 v12, 0xffff0000, v127
    v_sub_f32 v12, v12, v13
    v_mul_f32 v12, v12, v8
    v_cvt_pk_bf16_f32 v127, v9, v12
    s_mov_b32 s6, s3
    s_mov_b32 s25, 0x3d922279
    s_mov_b32 s26, 0x40135761
m1_34:
    s_lshl_b32 s7, s6, 14
    s_add_u32 s7, s7, 25165824
    s_add_u32 s8, s7, 0
    buffer_load_dwordx4 v[128:131], v6, s[48:51], s8 offen offset:0
    buffer_load_dwordx4 v[132:135], v6, s[48:51], s8 offen offset:1024
    buffer_load_dwordx4 v[136:139], v6, s[48:51], s8 offen offset:2048
    buffer_load_dwordx4 v[140:143], v6, s[48:51], s8 offen offset:3072
    s_add_u32 s8, s7, 4096
    buffer_load_dwordx4 v[144:147], v6, s[48:51], s8 offen offset:0
    buffer_load_dwordx4 v[148:151], v6, s[48:51], s8 offen offset:1024
    buffer_load_dwordx4 v[152:155], v6, s[48:51], s8 offen offset:2048
    buffer_load_dwordx4 v[156:159], v6, s[48:51], s8 offen offset:3072
    s_add_u32 s8, s7, 8192
    buffer_load_dwordx4 v[160:163], v6, s[48:51], s8 offen offset:0
    buffer_load_dwordx4 v[164:167], v6, s[48:51], s8 offen offset:1024
    buffer_load_dwordx4 v[168:171], v6, s[48:51], s8 offen offset:2048
    buffer_load_dwordx4 v[172:175], v6, s[48:51], s8 offen offset:3072
    s_add_u32 s8, s7, 12288
    buffer_load_dwordx4 v[176:179], v6, s[48:51], s8 offen offset:0
    buffer_load_dwordx4 v[180:183], v6, s[48:51], s8 offen offset:1024
    buffer_load_dwordx4 v[184:187], v6, s[48:51], s8 offen offset:2048
    buffer_load_dwordx4 v[188:191], v6, s[48:51], s8 offen offset:3072
    s_lshl_b32 s8, s6, 5
    v_lshlrev_b32 v9, 1, v4
    buffer_load_ushort v16, v9, s[56:59], s8 offen
    s_waitcnt vmcnt(0)
    v_lshlrev_b32 v16, 16, v16
    v_mfma_f32_16x16x32_bf16 v[20:23], v[64:67], v[128:131], 0
    v_mfma_f32_16x16x32_bf16 v[20:23], v[68:71], v[132:135], v[20:23]
    v_mfma_f32_16x16x32_bf16 v[20:23], v[72:75], v[136:139], v[20:23]
    v_mfma_f32_16x16x32_bf16 v[20:23], v[76:79], v[140:143], v[20:23]
    v_mfma_f32_16x16x32_bf16 v[20:23], v[80:83], v[144:147], v[20:23]
    v_mfma_f32_16x16x32_bf16 v[20:23], v[84:87], v[148:151], v[20:23]
    v_mfma_f32_16x16x32_bf16 v[20:23], v[88:91], v[152:155], v[20:23]
    v_mfma_f32_16x16x32_bf16 v[20:23], v[92:95], v[156:159], v[20:23]
    v_mfma_f32_16x16x32_bf16 v[20:23], v[96:99], v[160:163], v[20:23]
    v_mfma_f32_16x16x32_bf16 v[20:23], v[100:103], v[164:167], v[20:23]
    v_mfma_f32_16x16x32_bf16 v[20:23], v[104:107], v[168:171], v[20:23]
    v_mfma_f32_16x16x32_bf16 v[20:23], v[108:111], v[172:175], v[20:23]
    v_mfma_f32_16x16x32_bf16 v[20:23], v[112:115], v[176:179], v[20:23]
    v_mfma_f32_16x16x32_bf16 v[20:23], v[116:119], v[180:183], v[20:23]
    v_mfma_f32_16x16x32_bf16 v[20:23], v[120:123], v[184:187], v[20:23]
    v_mfma_f32_16x16x32_bf16 v[20:23], v[124:127], v[188:191], v[20:23]
    s_nop 7
    v_mul_u32_u24 v9, 11072, v3
    v_lshl_add_u32 v9, v4, 1, v9
    v_add_u32 v9, s8, v9
    v_add_f32 v20, v20, v16
    v_mul_f32 v12, v20, v20
    v_fma_f32 v12, v12, s25, 1.0
    v_mul_f32 v12, v12, v20
    v_mul_f32 v12, s26, v12
    v_exp_f32 v12, -v12
    s_nop 0
    v_add_f32 v12, 1.0, v12
    v_rcp_f32 v12, v12
    s_nop 0
    v_mul_f32 v12, v12, v20
    v_cvt_pk_bf16_f32 v12, v12, v12
    ds_write_b16 v9, v12 offset:0
    v_add_f32 v21, v21, v16
    v_mul_f32 v12, v21, v21
    v_fma_f32 v12, v12, s25, 1.0
    v_mul_f32 v12, v12, v21
    v_mul_f32 v12, s26, v12
    v_exp_f32 v12, -v12
    s_nop 0
    v_add_f32 v12, 1.0, v12
    v_rcp_f32 v12, v12
    s_nop 0
    v_mul_f32 v12, v12, v21
    v_cvt_pk_bf16_f32 v12, v12, v12
    ds_write_b16 v9, v12 offset:2768
    v_add_f32 v22, v22, v16
    v_mul_f32 v12, v22, v22
    v_fma_f32 v12, v12, s25, 1.0
    v_mul_f32 v12, v12, v22
    v_mul_f32 v12, s26, v12
    v_exp_f32 v12, -v12
    s_nop 0
    v_add_f32 v12, 1.0, v12
    v_rcp_f32 v12, v12
    s_nop 0
    v_mul_f32 v12, v12, v22
    v_cvt_pk_bf16_f32 v12, v12, v12
    ds_write_b16 v9, v12 offset:5536
    v_add_f32 v23, v23, v16
    v_mul_f32 v12, v23, v23
    v_fma_f32 v12, v12, s25, 1.0
    v_mul_f32 v12, v12, v23
    v_mul_f32 v12, s26, v12
    v_exp_f32 v12, -v12
    s_nop 0
    v_add_f32 v12, 1.0, v12
    v_rcp_f32 v12, v12
    s_nop 0
    v_mul_f32 v12, v12, v23
    v_cvt_pk_bf16_f32 v12, v12, v12
    ds_write_b16 v9, v12 offset:8304
    s_add_u32 s6, s6, 4
    s_cmp_lt_u32 s6, 86
    s_cbranch_scc1 m1_34
    s_waitcnt lgkmcnt(0)
    s_barrier
    v_mul_u32_u24 v9, 2768, v4
    v_lshl_add_u32 v9, v3, 4, v9
    s_mov_b32 s6, 0
    s_mul_i32 s7, s3, 352256
    s_add_u32 s7, s7, 27262976
    v_mov_b32 v32, 0
    v_mov_b32 v33, 0
    v_mov_b32 v34, 0
    v_mov_b32 v35, 0
    v_mov_b32 v36, 0
    v_mov_b32 v37, 0
    v_mov_b32 v38, 0
    v_mov_b32 v39, 0
    v_mov_b32 v40, 0
    v_mov_b32 v41, 0
    v_mov_b32 v42, 0
    v_mov_b32 v43, 0
    v_mov_b32 v44, 0
    v_mov_b32 v45, 0
    v_mov_b32 v46, 0
    v_mov_b32 v47, 0
    v_mov_b32 v48, 0
    v_mov_b32 v49, 0
    v_mov_b32 v50, 0
    v_mov_b32 v51, 0
    v_mov_b32 v52, 0
    v_mov_b32 v53, 0
    v_mov_b32 v54, 0
    v_mov_b32 v55, 0
    v_mov_b32 v56, 0
    v_mov_b32 v57, 0
    v_mov_b32 v58, 0
    v_mov_b32 v59, 0
    v_mov_b32 v60, 0
    v_mov_b32 v61, 0
    v_mov_b32 v62, 0
    v_mov_b32 v63, 0
m2_35:
    ds_read_b128 v[16:19], v9
    s_add_u32 s8, s7, 0
    buffer_load_dwordx4 v[64:67], v6, s[48:51], s8 offen
    s_add_u32 s8, s7, 44032
    buffer_load_dwordx4 v[68:71], v6, s[48:51], s8 offen
    s_add_u32 s8, s7, 88064
    buffer_load_dwordx4 v[72:75], v6, s[48:51], s8 offen
    s_add_u32 s8, s7, 132096
    buffer_load_dwordx4 v[76:79], v6, s[48:51], s8 offen
    s_add_u32 s8, s7, 176128
    buffer_load_dwordx4 v[80:83], v6, s[48:51], s8 offen
    s_add_u32 s8, s7, 220160
    buffer_load_dwordx4 v[84:87], v6, s[48:51], s8 offen
    s_add_u32 s8, s7, 264192
    buffer_load_dwordx4 v[88:91], v6, s[48:51], s8 offen
    s_add_u32 s8, s7, 308224
    buffer_load_dwordx4 v[92:95], v6, s[48:51], s8 offen
    s_waitcnt vmcnt(0) lgkmcnt(0)
    v_mfma_f32_16x16x32_bf16 v[32:35], v[16:19], v[64:67], v[32:35]
    v_mfma_f32_16x16x32_bf16 v[36:39], v[16:19], v[68:71], v[36:39]
    v_mfma_f32_16x16x32_bf16 v[40:43], v[16:19], v[72:75], v[40:43]
    v_mfma_f32_16x16x32_bf16 v[44:47], v[16:19], v[76:79], v[44:47]
    v_mfma_f32_16x16x32_bf16 v[48:51], v[16:19], v[80:83], v[48:51]
    v_mfma_f32_16x16x32_bf16 v[52:55], v[16:19], v[84:87], v[52:55]
    v_mfma_f32_16x16x32_bf16 v[56:59], v[16:19], v[88:91], v[56:59]
    v_mfma_f32_16x16x32_bf16 v[60:63], v[16:19], v[92:95], v[60:63]
    v_add_u32 v9, 64, v9
    s_add_u32 s7, s7, 1024
    s_add_u32 s6, s6, 1
    s_cmp_lt_u32 s6, 43
    s_cbranch_scc1 m2_35
    s_nop 7
    s_nop 7
    s_lshl_b32 s8, s3, 8
    v_lshlrev_b32 v9, 1, v4
    v_lshlrev_b32 v14, 2, v3
    v_add_u32 v14, s5, v14
    v_lshlrev_b32 v14, 10, v14
    v_lshl_add_u32 v14, v4, 1, v14
    v_add_u32 v14, s8, v14
    v_add_u32 v14, 2097152, v14
    s_mov_b32 s9, 0xbfb8aa3b
    buffer_load_ushort v16, v9, s[60:63], s8 offen offset:0
    s_waitcnt vmcnt(0)
    v_lshlrev_b32 v16, 16, v16
    v_add_f32 v32, v32, v16
    v_cvt_pk_bf16_f32 v32, v32, v32
    v_lshlrev_b32 v32, 16, v32
    v_mul_f32 v12, s9, v32
    v_exp_f32 v12, v12
    s_nop 0
    v_add_f32 v12, 1.0, v12
    v_rcp_f32 v12, v12
    s_nop 0
    v_mul_f32 v12, v12, v32
    v_cvt_pk_bf16_f32 v12, v12, v12
    buffer_store_short v12, v14, s[48:51], 0 offen offset:0
    v_add_f32 v33, v33, v16
    v_cvt_pk_bf16_f32 v33, v33, v33
    v_lshlrev_b32 v33, 16, v33
    v_mul_f32 v12, s9, v33
    v_exp_f32 v12, v12
    s_nop 0
    v_add_f32 v12, 1.0, v12
    v_rcp_f32 v12, v12
    s_nop 0
    v_mul_f32 v12, v12, v33
    v_cvt_pk_bf16_f32 v12, v12, v12
    buffer_store_short v12, v14, s[48:51], 0 offen offset:1024
    v_add_f32 v34, v34, v16
    v_cvt_pk_bf16_f32 v34, v34, v34
    v_lshlrev_b32 v34, 16, v34
    v_mul_f32 v12, s9, v34
    v_exp_f32 v12, v12
    s_nop 0
    v_add_f32 v12, 1.0, v12
    v_rcp_f32 v12, v12
    s_nop 0
    v_mul_f32 v12, v12, v34
    v_cvt_pk_bf16_f32 v12, v12, v12
    buffer_store_short v12, v14, s[48:51], 0 offen offset:2048
    v_add_f32 v35, v35, v16
    v_cvt_pk_bf16_f32 v35, v35, v35
    v_lshlrev_b32 v35, 16, v35
    v_mul_f32 v12, s9, v35
    v_exp_f32 v12, v12
    s_nop 0
    v_add_f32 v12, 1.0, v12
    v_rcp_f32 v12, v12
    s_nop 0
    v_mul_f32 v12, v12, v35
    v_cvt_pk_bf16_f32 v12, v12, v12
    buffer_store_short v12, v14, s[48:51], 0 offen offset:3072
    buffer_load_ushort v16, v9, s[60:63], s8 offen offset:32
    s_waitcnt vmcnt(0)
    v_lshlrev_b32 v16, 16, v16
    v_add_f32 v36, v36, v16
    v_cvt_pk_bf16_f32 v36, v36, v36
    v_lshlrev_b32 v36, 16, v36
    v_mul_f32 v12, s9, v36
    v_exp_f32 v12, v12
    s_nop 0
    v_add_f32 v12, 1.0, v12
    v_rcp_f32 v12, v12
    s_nop 0
    v_mul_f32 v12, v12, v36
    v_cvt_pk_bf16_f32 v12, v12, v12
    buffer_store_short v12, v14, s[48:51], 0 offen offset:32
    v_add_f32 v37, v37, v16
    v_cvt_pk_bf16_f32 v37, v37, v37
    v_lshlrev_b32 v37, 16, v37
    v_mul_f32 v12, s9, v37
    v_exp_f32 v12, v12
    s_nop 0
    v_add_f32 v12, 1.0, v12
    v_rcp_f32 v12, v12
    s_nop 0
    v_mul_f32 v12, v12, v37
    v_cvt_pk_bf16_f32 v12, v12, v12
    buffer_store_short v12, v14, s[48:51], 0 offen offset:1056
    v_add_f32 v38, v38, v16
    v_cvt_pk_bf16_f32 v38, v38, v38
    v_lshlrev_b32 v38, 16, v38
    v_mul_f32 v12, s9, v38
    v_exp_f32 v12, v12
    s_nop 0
    v_add_f32 v12, 1.0, v12
    v_rcp_f32 v12, v12
    s_nop 0
    v_mul_f32 v12, v12, v38
    v_cvt_pk_bf16_f32 v12, v12, v12
    buffer_store_short v12, v14, s[48:51], 0 offen offset:2080
    v_add_f32 v39, v39, v16
    v_cvt_pk_bf16_f32 v39, v39, v39
    v_lshlrev_b32 v39, 16, v39
    v_mul_f32 v12, s9, v39
    v_exp_f32 v12, v12
    s_nop 0
    v_add_f32 v12, 1.0, v12
    v_rcp_f32 v12, v12
    s_nop 0
    v_mul_f32 v12, v12, v39
    v_cvt_pk_bf16_f32 v12, v12, v12
    buffer_store_short v12, v14, s[48:51], 0 offen offset:3104
    buffer_load_ushort v16, v9, s[60:63], s8 offen offset:64
    s_waitcnt vmcnt(0)
    v_lshlrev_b32 v16, 16, v16
    v_add_f32 v40, v40, v16
    v_cvt_pk_bf16_f32 v40, v40, v40
    v_lshlrev_b32 v40, 16, v40
    v_mul_f32 v12, s9, v40
    v_exp_f32 v12, v12
    s_nop 0
    v_add_f32 v12, 1.0, v12
    v_rcp_f32 v12, v12
    s_nop 0
    v_mul_f32 v12, v12, v40
    v_cvt_pk_bf16_f32 v12, v12, v12
    buffer_store_short v12, v14, s[48:51], 0 offen offset:64
    v_add_f32 v41, v41, v16
    v_cvt_pk_bf16_f32 v41, v41, v41
    v_lshlrev_b32 v41, 16, v41
    v_mul_f32 v12, s9, v41
    v_exp_f32 v12, v12
    s_nop 0
    v_add_f32 v12, 1.0, v12
    v_rcp_f32 v12, v12
    s_nop 0
    v_mul_f32 v12, v12, v41
    v_cvt_pk_bf16_f32 v12, v12, v12
    buffer_store_short v12, v14, s[48:51], 0 offen offset:1088
    v_add_f32 v42, v42, v16
    v_cvt_pk_bf16_f32 v42, v42, v42
    v_lshlrev_b32 v42, 16, v42
    v_mul_f32 v12, s9, v42
    v_exp_f32 v12, v12
    s_nop 0
    v_add_f32 v12, 1.0, v12
    v_rcp_f32 v12, v12
    s_nop 0
    v_mul_f32 v12, v12, v42
    v_cvt_pk_bf16_f32 v12, v12, v12
    buffer_store_short v12, v14, s[48:51], 0 offen offset:2112
    v_add_f32 v43, v43, v16
    v_cvt_pk_bf16_f32 v43, v43, v43
    v_lshlrev_b32 v43, 16, v43
    v_mul_f32 v12, s9, v43
    v_exp_f32 v12, v12
    s_nop 0
    v_add_f32 v12, 1.0, v12
    v_rcp_f32 v12, v12
    s_nop 0
    v_mul_f32 v12, v12, v43
    v_cvt_pk_bf16_f32 v12, v12, v12
    buffer_store_short v12, v14, s[48:51], 0 offen offset:3136
    buffer_load_ushort v16, v9, s[60:63], s8 offen offset:96
    s_waitcnt vmcnt(0)
    v_lshlrev_b32 v16, 16, v16
    v_add_f32 v44, v44, v16
    v_cvt_pk_bf16_f32 v44, v44, v44
    v_lshlrev_b32 v44, 16, v44
    v_mul_f32 v12, s9, v44
    v_exp_f32 v12, v12
    s_nop 0
    v_add_f32 v12, 1.0, v12
    v_rcp_f32 v12, v12
    s_nop 0
    v_mul_f32 v12, v12, v44
    v_cvt_pk_bf16_f32 v12, v12, v12
    buffer_store_short v12, v14, s[48:51], 0 offen offset:96
    v_add_f32 v45, v45, v16
    v_cvt_pk_bf16_f32 v45, v45, v45
    v_lshlrev_b32 v45, 16, v45
    v_mul_f32 v12, s9, v45
    v_exp_f32 v12, v12
    s_nop 0
    v_add_f32 v12, 1.0, v12
    v_rcp_f32 v12, v12
    s_nop 0
    v_mul_f32 v12, v12, v45
    v_cvt_pk_bf16_f32 v12, v12, v12
    buffer_store_short v12, v14, s[48:51], 0 offen offset:1120
    v_add_f32 v46, v46, v16
    v_cvt_pk_bf16_f32 v46, v46, v46
    v_lshlrev_b32 v46, 16, v46
    v_mul_f32 v12, s9, v46
    v_exp_f32 v12, v12
    s_nop 0
    v_add_f32 v12, 1.0, v12
    v_rcp_f32 v12, v12
    s_nop 0
    v_mul_f32 v12, v12, v46
    v_cvt_pk_bf16_f32 v12, v12, v12
    buffer_store_short v12, v14, s[48:51], 0 offen offset:2144
    v_add_f32 v47, v47, v16
    v_cvt_pk_bf16_f32 v47, v47, v47
    v_lshlrev_b32 v47, 16, v47
    v_mul_f32 v12, s9, v47
    v_exp_f32 v12, v12
    s_nop 0
    v_add_f32 v12, 1.0, v12
    v_rcp_f32 v12, v12
    s_nop 0
    v_mul_f32 v12, v12, v47
    v_cvt_pk_bf16_f32 v12, v12, v12
    buffer_store_short v12, v14, s[48:51], 0 offen offset:3168
    buffer_load_ushort v16, v9, s[60:63], s8 offen offset:128
    s_waitcnt vmcnt(0)
    v_lshlrev_b32 v16, 16, v16
    v_add_f32 v48, v48, v16
    v_cvt_pk_bf16_f32 v48, v48, v48
    v_lshlrev_b32 v48, 16, v48
    v_mul_f32 v12, s9, v48
    v_exp_f32 v12, v12
    s_nop 0
    v_add_f32 v12, 1.0, v12
    v_rcp_f32 v12, v12
    s_nop 0
    v_mul_f32 v12, v12, v48
    v_cvt_pk_bf16_f32 v12, v12, v12
    buffer_store_short v12, v14, s[48:51], 0 offen offset:128
    v_add_f32 v49, v49, v16
    v_cvt_pk_bf16_f32 v49, v49, v49
    v_lshlrev_b32 v49, 16, v49
    v_mul_f32 v12, s9, v49
    v_exp_f32 v12, v12
    s_nop 0
    v_add_f32 v12, 1.0, v12
    v_rcp_f32 v12, v12
    s_nop 0
    v_mul_f32 v12, v12, v49
    v_cvt_pk_bf16_f32 v12, v12, v12
    buffer_store_short v12, v14, s[48:51], 0 offen offset:1152
    v_add_f32 v50, v50, v16
    v_cvt_pk_bf16_f32 v50, v50, v50
    v_lshlrev_b32 v50, 16, v50
    v_mul_f32 v12, s9, v50
    v_exp_f32 v12, v12
    s_nop 0
    v_add_f32 v12, 1.0, v12
    v_rcp_f32 v12, v12
    s_nop 0
    v_mul_f32 v12, v12, v50
    v_cvt_pk_bf16_f32 v12, v12, v12
    buffer_store_short v12, v14, s[48:51], 0 offen offset:2176
    v_add_f32 v51, v51, v16
    v_cvt_pk_bf16_f32 v51, v51, v51
    v_lshlrev_b32 v51, 16, v51
    v_mul_f32 v12, s9, v51
    v_exp_f32 v12, v12
    s_nop 0
    v_add_f32 v12, 1.0, v12
    v_rcp_f32 v12, v12
    s_nop 0
    v_mul_f32 v12, v12, v51
    v_cvt_pk_bf16_f32 v12, v12, v12
    buffer_store_short v12, v14, s[48:51], 0 offen offset:3200
    buffer_load_ushort v16, v9, s[60:63], s8 offen offset:160
    s_waitcnt vmcnt(0)
    v_lshlrev_b32 v16, 16, v16
    v_add_f32 v52, v52, v16
    v_cvt_pk_bf16_f32 v52, v52, v52
    v_lshlrev_b32 v52, 16, v52
    v_mul_f32 v12, s9, v52
    v_exp_f32 v12, v12
    s_nop 0
    v_add_f32 v12, 1.0, v12
    v_rcp_f32 v12, v12
    s_nop 0
    v_mul_f32 v12, v12, v52
    v_cvt_pk_bf16_f32 v12, v12, v12
    buffer_store_short v12, v14, s[48:51], 0 offen offset:160
    v_add_f32 v53, v53, v16
    v_cvt_pk_bf16_f32 v53, v53, v53
    v_lshlrev_b32 v53, 16, v53
    v_mul_f32 v12, s9, v53
    v_exp_f32 v12, v12
    s_nop 0
    v_add_f32 v12, 1.0, v12
    v_rcp_f32 v12, v12
    s_nop 0
    v_mul_f32 v12, v12, v53
    v_cvt_pk_bf16_f32 v12, v12, v12
    buffer_store_short v12, v14, s[48:51], 0 offen offset:1184
    v_add_f32 v54, v54, v16
    v_cvt_pk_bf16_f32 v54, v54, v54
    v_lshlrev_b32 v54, 16, v54
    v_mul_f32 v12, s9, v54
    v_exp_f32 v12, v12
    s_nop 0
    v_add_f32 v12, 1.0, v12
    v_rcp_f32 v12, v12
    s_nop 0
    v_mul_f32 v12, v12, v54
    v_cvt_pk_bf16_f32 v12, v12, v12
    buffer_store_short v12, v14, s[48:51], 0 offen offset:2208
    v_add_f32 v55, v55, v16
    v_cvt_pk_bf16_f32 v55, v55, v55
    v_lshlrev_b32 v55, 16, v55
    v_mul_f32 v12, s9, v55
    v_exp_f32 v12, v12
    s_nop 0
    v_add_f32 v12, 1.0, v12
    v_rcp_f32 v12, v12
    s_nop 0
    v_mul_f32 v12, v12, v55
    v_cvt_pk_bf16_f32 v12, v12, v12
    buffer_store_short v12, v14, s[48:51], 0 offen offset:3232
    buffer_load_ushort v16, v9, s[60:63], s8 offen offset:192
    s_waitcnt vmcnt(0)
    v_lshlrev_b32 v16, 16, v16
    v_add_f32 v56, v56, v16
    v_cvt_pk_bf16_f32 v56, v56, v56
    v_lshlrev_b32 v56, 16, v56
    v_mul_f32 v12, s9, v56
    v_exp_f32 v12, v12
    s_nop 0
    v_add_f32 v12, 1.0, v12
    v_rcp_f32 v12, v12
    s_nop 0
    v_mul_f32 v12, v12, v56
    v_cvt_pk_bf16_f32 v12, v12, v12
    buffer_store_short v12, v14, s[48:51], 0 offen offset:192
    v_add_f32 v57, v57, v16
    v_cvt_pk_bf16_f32 v57, v57, v57
    v_lshlrev_b32 v57, 16, v57
    v_mul_f32 v12, s9, v57
    v_exp_f32 v12, v12
    s_nop 0
    v_add_f32 v12, 1.0, v12
    v_rcp_f32 v12, v12
    s_nop 0
    v_mul_f32 v12, v12, v57
    v_cvt_pk_bf16_f32 v12, v12, v12
    buffer_store_short v12, v14, s[48:51], 0 offen offset:1216
    v_add_f32 v58, v58, v16
    v_cvt_pk_bf16_f32 v58, v58, v58
    v_lshlrev_b32 v58, 16, v58
    v_mul_f32 v12, s9, v58
    v_exp_f32 v12, v12
    s_nop 0
    v_add_f32 v12, 1.0, v12
    v_rcp_f32 v12, v12
    s_nop 0
    v_mul_f32 v12, v12, v58
    v_cvt_pk_bf16_f32 v12, v12, v12
    buffer_store_short v12, v14, s[48:51], 0 offen offset:2240
    v_add_f32 v59, v59, v16
    v_cvt_pk_bf16_f32 v59, v59, v59
    v_lshlrev_b32 v59, 16, v59
    v_mul_f32 v12, s9, v59
    v_exp_f32 v12, v12
    s_nop 0
    v_add_f32 v12, 1.0, v12
    v_rcp_f32 v12, v12
    s_nop 0
    v_mul_f32 v12, v12, v59
    v_cvt_pk_bf16_f32 v12, v12, v12
    buffer_store_short v12, v14, s[48:51], 0 offen offset:3264
    buffer_load_ushort v16, v9, s[60:63], s8 offen offset:224
    s_waitcnt vmcnt(0)
    v_lshlrev_b32 v16, 16, v16
    v_add_f32 v60, v60, v16
    v_cvt_pk_bf16_f32 v60, v60, v60
    v_lshlrev_b32 v60, 16, v60
    v_mul_f32 v12, s9, v60
    v_exp_f32 v12, v12
    s_nop 0
    v_add_f32 v12, 1.0, v12
    v_rcp_f32 v12, v12
    s_nop 0
    v_mul_f32 v12, v12, v60
    v_cvt_pk_bf16_f32 v12, v12, v12
    buffer_store_short v12, v14, s[48:51], 0 offen offset:224
    v_add_f32 v61, v61, v16
    v_cvt_pk_bf16_f32 v61, v61, v61
    v_lshlrev_b32 v61, 16, v61
    v_mul_f32 v12, s9, v61
    v_exp_f32 v12, v12
    s_nop 0
    v_add_f32 v12, 1.0, v12
    v_rcp_f32 v12, v12
    s_nop 0
    v_mul_f32 v12, v12, v61
    v_cvt_pk_bf16_f32 v12, v12, v12
    buffer_store_short v12, v14, s[48:51], 0 offen offset:1248
    v_add_f32 v62, v62, v16
    v_cvt_pk_bf16_f32 v62, v62, v62
    v_lshlrev_b32 v62, 16, v62
    v_mul_f32 v12, s9, v62
    v_exp_f32 v12, v12
    s_nop 0
    v_add_f32 v12, 1.0, v12
    v_rcp_f32 v12, v12
    s_nop 0
    v_mul_f32 v12, v12, v62
    v_cvt_pk_bf16_f32 v12, v12, v12
    buffer_store_short v12, v14, s[48:51], 0 offen offset:2272
    v_add_f32 v63, v63, v16
    v_cvt_pk_bf16_f32 v63, v63, v63
    v_lshlrev_b32 v63, 16, v63
    v_mul_f32 v12, s9, v63
    v_exp_f32 v12, v12
    s_nop 0
    v_add_f32 v12, 1.0, v12
    v_rcp_f32 v12, v12
    s_nop 0
    v_mul_f32 v12, v12, v63
    v_cvt_pk_bf16_f32 v12, v12, v12
    buffer_store_short v12, v14, s[48:51], 0 offen offset:3296
    s_branch k3_end
k3_end:
    s_endpgm
    .globl k4_kernel
    .p2align 8
    .type k4_kernel,@function
k4_kernel:
    s_cmp_ge_u32 s2, 512
    s_cbranch_scc1 k4_end
    s_load_dwordx2 s[32:33], s[0:1], 112
    v_lshrrev_b32 v1, 6, v0
    v_and_b32 v2, 63, v0
    v_readfirstlane_b32 s3, v1
    s_waitcnt lgkmcnt(0)
    s_mov_b32 s48, s32
    s_and_b32 s49, s33, 0xffff
    s_mov_b32 s50, 268435456
    s_mov_b32 s51, 0x00020000
    v_lshrrev_b32 v3, 4, v2
    v_and_b32 v4, 15, v2
    v_and_b32 v5, 7, v2
    s_lshl_b32 s4, s2, 2
    s_add_u32 s4, s4, s3
    s_lshr_b32 s12, s4, 5
    s_and_b32 s5, s4, 31
    s_lshl_b32 s13, s12, 5
    v_add_u32 v8, s13, v4
    v_lshlrev_b32 v8, 13, v8
    v_lshl_add_u32 v8, v3, 4, v8
    s_lshl_b32 s14, s5, 8
    s_add_u32 s15, s14, 50331648
    buffer_load_dwordx4 v[32:35], v8, s[48:51], s15 offen offset:0
    s_add_u32 s15, s14, 33554432
    buffer_load_dwordx4 v[64:67], v8, s[48:51], s15 offen offset:0
    s_add_u32 s15, s14, 50331648
    buffer_load_dwordx4 v[36:39], v8, s[48:51], s15 offen offset:64
    s_add_u32 s15, s14, 33554432
    buffer_load_dwordx4 v[68:71], v8, s[48:51], s15 offen offset:64
    s_add_u32 s15, s14, 50331648
    buffer_load_dwordx4 v[40:43], v8, s[48:51], s15 offen offset:128
    s_add_u32 s15, s14, 33554432
    buffer_load_dwordx4 v[72:75], v8, s[48:51], s15 offen offset:128
    s_add_u32 s15, s14, 50331648
    buffer_load_dwordx4 v[44:47], v8, s[48:51], s15 offen offset:192
    s_add_u32 s15, s14, 33554432
    buffer_load_dwordx4 v[76:79], v8, s[48:51], s15 offen offset:192
    s_add_u32 s15, s14, 50462720
    buffer_load_dwordx4 v[48:51], v8, s[48:51], s15 offen offset:0
    s_add_u32 s15, s14, 33685504
    buffer_load_dwordx4 v[80:83], v8, s[48:51], s15 offen offset:0
    s_add_u32 s15, s14, 50462720
    buffer_load_dwordx4 v[52:55], v8, s[48:51], s15 offen offset:64
    s_add_u32 s15, s14, 33685504
    buffer_load_dwordx4 v[84:87], v8, s[48:51], s15 offen offset:64
    s_add_u32 s15, s14, 50462720
    buffer_load_dwordx4 v[56:59], v8, s[48:51], s15 offen offset:128
    s_add_u32 s15, s14, 33685504
    buffer_load_dwordx4 v[88:91], v8, s[48:51], s15 offen offset:128
    s_add_u32 s15, s14, 50462720
    buffer_load_dwordx4 v[60:63], v8, s[48:51], s15 offen offset:192
    s_add_u32 s15, s14, 33685504
    buffer_load_dwordx4 v[92:95], v8, s[48:51], s15 offen offset:192
    v_lshlrev_b32 v9, 13, v5
    v_lshl_add_u32 v9, v3, 4, v9
    s_lshl_b32 s15, s12, 16
    s_add_u32 s15, s15, s14
    s_add_u32 s15, s15, 83886080
    buffer_load_dwordx4 v[16:19], v9, s[48:51], s15 offen offset:0
    buffer_load_dwordx4 v[20:23], v9, s[48:51], s15 offen offset:64
    buffer_load_dwordx4 v[24:27], v9, s[48:51], s15 offen offset:128
    buffer_load_dwordx4 v[28:31], v9, s[48:51], s15 offen offset:192
    v_xor_b32 v10, 16, v2
    v_lshlrev_b32 v10, 2, v10
    v_xor_b32 v11, 32, v2
    v_lshlrev_b32 v11, 2, v11
    s_mov_b32 s24, 0x3e029e1e
    s_waitcnt vmcnt(0)
    v_mfma_f32_16x16x32_bf16 v[112:115], v[16:19], v[64:67], 0
    v_mfma_f32_16x16x32_bf16 v[112:115], v[20:23], v[68:71], v[112:115]
    v_mfma_f32_16x16x32_bf16 v[112:115], v[24:27], v[72:75], v[112:115]
    v_mfma_f32_16x16x32_bf16 v[112:115], v[28:31], v[76:79], v[112:115]
    v_mfma_f32_16x16x32_bf16 v[116:119], v[32:35], v[64:67], 0
    v_mfma_f32_16x16x32_bf16 v[116:119], v[36:39], v[68:71], v[116:119]
    v_mfma_f32_16x16x32_bf16 v[116:119], v[40:43], v[72:75], v[116:119]
    v_mfma_f32_16x16x32_bf16 v[116:119], v[44:47], v[76:79], v[116:119]
    v_mfma_f32_16x16x32_bf16 v[120:123], v[48:51], v[64:67], 0
    v_mfma_f32_16x16x32_bf16 v[120:123], v[52:55], v[68:71], v[120:123]
    v_mfma_f32_16x16x32_bf16 v[120:123], v[56:59], v[72:75], v[120:123]
    v_mfma_f32_16x16x32_bf16 v[120:123], v[60:63], v[76:79], v[120:123]
    s_nop 7
    v_mov_b32 v12, 0xff800000
    v_cmp_gt_u32 vcc, 2, v3
    s_nop 1
    v_cndmask_b32 v112, v12, v112, vcc
    v_cndmask_b32 v113, v12, v113, vcc
    v_cndmask_b32 v114, v12, v114, vcc
    v_cndmask_b32 v115, v12, v115, vcc
    v_lshl_add_u32 v13, v3, 2, 0
    v_subrev_u32 v13, 0, v13
    v_cmp_ge_i32 vcc, v4, v13
    s_nop 1
    v_cndmask_b32 v116, v12, v116, vcc
    v_lshl_add_u32 v13, v3, 2, 1
    v_subrev_u32 v13, 0, v13
    v_cmp_ge_i32 vcc, v4, v13
    s_nop 1
    v_cndmask_b32 v117, v12, v117, vcc
    v_lshl_add_u32 v13, v3, 2, 2
    v_subrev_u32 v13, 0, v13
    v_cmp_ge_i32 vcc, v4, v13
    s_nop 1
    v_cndmask_b32 v118, v12, v118, vcc
    v_lshl_add_u32 v13, v3, 2, 3
    v_subrev_u32 v13, 0, v13
    v_cmp_ge_i32 vcc, v4, v13
    s_nop 1
    v_cndmask_b32 v119, v12, v119, vcc
    v_lshl_add_u32 v13, v3, 2, 16
    v_subrev_u32 v13, 0, v13
    v_cmp_ge_i32 vcc, v4, v13
    s_nop 1
    v_cndmask_b32 v120, v12, v120, vcc
    v_lshl_add_u32 v13, v3, 2, 17
    v_subrev_u32 v13, 0, v13
    v_cmp_ge_i32 vcc, v4, v13
    s_nop 1
    v_cndmask_b32 v121, v12, v121, vcc
    v_lshl_add_u32 v13, v3, 2, 18
    v_subrev_u32 v13, 0, v13
    v_cmp_ge_i32 vcc, v4, v13
    s_nop 1
    v_cndmask_b32 v122, v12, v122, vcc
    v_lshl_add_u32 v13, v3, 2, 19
    v_subrev_u32 v13, 0, v13
    v_cmp_ge_i32 vcc, v4, v13
    s_nop 1
    v_cndmask_b32 v123, v12, v123, vcc
    v_max_f32 v9, v112, v113
    v_max_f32 v9, v9, v114
    v_max_f32 v9, v9, v115
    v_max_f32 v9, v9, v116
    v_max_f32 v9, v9, v117
    v_max_f32 v9, v9, v118
    v_max_f32 v9, v9, v119
    v_max_f32 v9, v9, v120
    v_max_f32 v9, v9, v121
    v_max_f32 v9, v9, v122
    v_max_f32 v9, v9, v123
    ds_bpermute_b32 v12, v10, v9
    s_waitcnt lgkmcnt(0)
    v_max_f32 v9, v9, v12
    ds_bpermute_b32 v12, v11, v9
    s_waitcnt lgkmcnt(0)
    v_max_f32 v9, v9, v12
    v_sub_f32 v112, v112, v9
    v_mul_f32 v112, s24, v112
    v_exp_f32 v112, v112
    v_sub_f32 v113, v113, v9
    v_mul_f32 v113, s24, v113
    v_exp_f32 v113, v113
    v_sub_f32 v114, v114, v9
    v_mul_f32 v114, s24, v114
    v_exp_f32 v114, v114
    v_sub_f32 v115, v115, v9
    v_mul_f32 v115, s24, v115
    v_exp_f32 v115, v115
    v_sub_f32 v116, v116, v9
    v_mul_f32 v116, s24, v116
    v_exp_f32 v116, v116
    v_sub_f32 v117, v117, v9
    v_mul_f32 v117, s24, v117
    v_exp_f32 v117, v117
    v_sub_f32 v118, v118, v9
    v_mul_f32 v118, s24, v118
    v_exp_f32 v118, v118
    v_sub_f32 v119, v119, v9
    v_mul_f32 v119, s24, v119
    v_exp_f32 v119, v119
    v_sub_f32 v120, v120, v9
    v_mul_f32 v120, s24, v120
    v_exp_f32 v120, v120
    v_sub_f32 v121, v121, v9
    v_mul_f32 v121, s24, v121
    v_exp_f32 v121, v121
    v_sub_f32 v122, v122, v9
    v_mul_f32 v122, s24, v122
    v_exp_f32 v122, v122
    v_sub_f32 v123, v123, v9
    v_mul_f32 v123, s24, v123
    v_exp_f32 v123, v123
    s_nop 0
    v_add_f32 v9, v112, v113
    v_add_f32 v9, v9, v114
    v_add_f32 v9, v9, v115
    v_add_f32 v9, v9, v116
    v_add_f32 v9, v9, v117
    v_add_f32 v9, v9, v118
    v_add_f32 v9, v9, v119
    v_add_f32 v9, v9, v120
    v_add_f32 v9, v9, v121
    v_add_f32 v9, v9, v122
    v_add_f32 v9, v9, v123
    ds_bpermute_b32 v12, v10, v9
    s_waitcnt lgkmcnt(0)
    v_add_f32 v9, v9, v12
    ds_bpermute_b32 v12, v11, v9
    s_waitcnt lgkmcnt(0)
    v_add_f32 v9, v9, v12
    v_rcp_f32 v9, v9
    s_nop 0
    v_mul_f32 v112, v112, v9
    v_mul_f32 v113, v113, v9
    v_mul_f32 v114, v114, v9
    v_mul_f32 v115, v115, v9
    v_mul_f32 v116, v116, v9
    v_mul_f32 v117, v117, v9
    v_mul_f32 v118, v118, v9
    v_mul_f32 v119, v119, v9
    v_mul_f32 v120, v120, v9
    v_mul_f32 v121, v121, v9
    v_mul_f32 v122, v122, v9
    v_mul_f32 v123, v123, v9
    v_cvt_pk_bf16_f32 v96, v116, v117
    v_cvt_pk_bf16_f32 v97, v118, v119
    v_cvt_pk_bf16_f32 v98, v120, v121
    v_cvt_pk_bf16_f32 v99, v122, v123
    v_cvt_pk_bf16_f32 v100, v112, v113
    v_cvt_pk_bf16_f32 v101, v114, v115
    v_mov_b32 v102, 0
    v_mov_b32 v103, 0
    v_mfma_f32_16x16x32_bf16 v[112:115], v[16:19], v[80:83], 0
    v_mfma_f32_16x16x32_bf16 v[112:115], v[20:23], v[84:87], v[112:115]
    v_mfma_f32_16x16x32_bf16 v[112:115], v[24:27], v[88:91], v[112:115]
    v_mfma_f32_16x16x32_bf16 v[112:115], v[28:31], v[92:95], v[112:115]
    v_mfma_f32_16x16x32_bf16 v[116:119], v[32:35], v[80:83], 0
    v_mfma_f32_16x16x32_bf16 v[116:119], v[36:39], v[84:87], v[116:119]
    v_mfma_f32_16x16x32_bf16 v[116:119], v[40:43], v[88:91], v[116:119]
    v_mfma_f32_16x16x32_bf16 v[116:119], v[44:47], v[92:95], v[116:119]
    v_mfma_f32_16x16x32_bf16 v[120:123], v[48:51], v[80:83], 0
    v_mfma_f32_16x16x32_bf16 v[120:123], v[52:55], v[84:87], v[120:123]
    v_mfma_f32_16x16x32_bf16 v[120:123], v[56:59], v[88:91], v[120:123]
    v_mfma_f32_16x16x32_bf16 v[120:123], v[60:63], v[92:95], v[120:123]
    s_nop 7
    v_mov_b32 v12, 0xff800000
    v_cmp_gt_u32 vcc, 2, v3
    s_nop 1
    v_cndmask_b32 v112, v12, v112, vcc
    v_cndmask_b32 v113, v12, v113, vcc
    v_cndmask_b32 v114, v12, v114, vcc
    v_cndmask_b32 v115, v12, v115, vcc
    v_lshl_add_u32 v13, v3, 2, 0
    v_subrev_u32 v13, 16, v13
    v_cmp_ge_i32 vcc, v4, v13
    s_nop 1
    v_cndmask_b32 v116, v12, v116, vcc
    v_lshl_add_u32 v13, v3, 2, 1
    v_subrev_u32 v13, 16, v13
    v_cmp_ge_i32 vcc, v4, v13
    s_nop 1
    v_cndmask_b32 v117, v12, v117, vcc
    v_lshl_add_u32 v13, v3, 2, 2
    v_subrev_u32 v13, 16, v13
    v_cmp_ge_i32 vcc, v4, v13
    s_nop 1
    v_cndmask_b32 v118, v12, v118, vcc
    v_lshl_add_u32 v13, v3, 2, 3
    v_subrev_u32 v13, 16, v13
    v_cmp_ge_i32 vcc, v4, v13
    s_nop 1
    v_cndmask_b32 v119, v12, v119, vcc
    v_lshl_add_u32 v13, v3, 2, 16
    v_subrev_u32 v13, 16, v13
    v_cmp_ge_i32 vcc, v4, v13
    s_nop 1
    v_cndmask_b32 v120, v12, v120, vcc
    v_lshl_add_u32 v13, v3, 2, 17
    v_subrev_u32 v13, 16, v13
    v_cmp_ge_i32 vcc, v4, v13
    s_nop 1
    v_cndmask_b32 v121, v12, v121, vcc
    v_lshl_add_u32 v13, v3, 2, 18
    v_subrev_u32 v13, 16, v13
    v_cmp_ge_i32 vcc, v4, v13
    s_nop 1
    v_cndmask_b32 v122, v12, v122, vcc
    v_lshl_add_u32 v13, v3, 2, 19
    v_subrev_u32 v13, 16, v13
    v_cmp_ge_i32 vcc, v4, v13
    s_nop 1
    v_cndmask_b32 v123, v12, v123, vcc
    v_max_f32 v9, v112, v113
    v_max_f32 v9, v9, v114
    v_max_f32 v9, v9, v115
    v_max_f32 v9, v9, v116
    v_max_f32 v9, v9, v117
    v_max_f32 v9, v9, v118
    v_max_f32 v9, v9, v119
    v_max_f32 v9, v9, v120
    v_max_f32 v9, v9, v121
    v_max_f32 v9, v9, v122
    v_max_f32 v9, v9, v123
    ds_bpermute_b32 v12, v10, v9
    s_waitcnt lgkmcnt(0)
    v_max_f32 v9, v9, v12
    ds_bpermute_b32 v12, v11, v9
    s_waitcnt lgkmcnt(0)
    v_max_f32 v9, v9, v12
    v_sub_f32 v112, v112, v9
    v_mul_f32 v112, s24, v112
    v_exp_f32 v112, v112
    v_sub_f32 v113, v113, v9
    v_mul_f32 v113, s24, v113
    v_exp_f32 v113, v113
    v_sub_f32 v114, v114, v9
    v_mul_f32 v114, s24, v114
    v_exp_f32 v114, v114
    v_sub_f32 v115, v115, v9
    v_mul_f32 v115, s24, v115
    v_exp_f32 v115, v115
    v_sub_f32 v116, v116, v9
    v_mul_f32 v116, s24, v116
    v_exp_f32 v116, v116
    v_sub_f32 v117, v117, v9
    v_mul_f32 v117, s24, v117
    v_exp_f32 v117, v117
    v_sub_f32 v118, v118, v9
    v_mul_f32 v118, s24, v118
    v_exp_f32 v118, v118
    v_sub_f32 v119, v119, v9
    v_mul_f32 v119, s24, v119
    v_exp_f32 v119, v119
    v_sub_f32 v120, v120, v9
    v_mul_f32 v120, s24, v120
    v_exp_f32 v120, v120
    v_sub_f32 v121, v121, v9
    v_mul_f32 v121, s24, v121
    v_exp_f32 v121, v121
    v_sub_f32 v122, v122, v9
    v_mul_f32 v122, s24, v122
    v_exp_f32 v122, v122
    v_sub_f32 v123, v123, v9
    v_mul_f32 v123, s24, v123
    v_exp_f32 v123, v123
    s_nop 0
    v_add_f32 v9, v112, v113
    v_add_f32 v9, v9, v114
    v_add_f32 v9, v9, v115
    v_add_f32 v9, v9, v116
    v_add_f32 v9, v9, v117
    v_add_f32 v9, v9, v118
    v_add_f32 v9, v9, v119
    v_add_f32 v9, v9, v120
    v_add_f32 v9, v9, v121
    v_add_f32 v9, v9, v122
    v_add_f32 v9, v9, v123
    ds_bpermute_b32 v12, v10, v9
    s_waitcnt lgkmcnt(0)
    v_add_f32 v9, v9, v12
    ds_bpermute_b32 v12, v11, v9
    s_waitcnt lgkmcnt(0)
    v_add_f32 v9, v9, v12
    v_rcp_f32 v9, v9
    s_nop 0
    v_mul_f32 v112, v112, v9
    v_mul_f32 v113, v113, v9
    v_mul_f32 v114, v114, v9
    v_mul_f32 v115, v115, v9
    v_mul_f32 v116, v116, v9
    v_mul_f32 v117, v117, v9
    v_mul_f32 v118, v118, v9
    v_mul_f32 v119, v119, v9
    v_mul_f32 v120, v120, v9
    v_mul_f32 v121, v121, v9
    v_mul_f32 v122, v122, v9
    v_mul_f32 v123, v123, v9
    v_cvt_pk_bf16_f32 v104, v116, v117
    v_cvt_pk_bf16_f32 v105, v118, v119
    v_cvt_pk_bf16_f32 v106, v120, v121
    v_cvt_pk_bf16_f32 v107, v122, v123
    v_cvt_pk_bf16_f32 v108, v112, v113
    v_cvt_pk_bf16_f32 v109, v114, v115
    v_mov_b32 v110, 0
    v_mov_b32 v111, 0
    s_lshl_b32 s15, s5, 7
    v_add_u32 v8, s15, v4
    v_lshlrev_b32 v13, 4, v8
    v_lshl_add_u32 v13, v3, 3, v13
    v_lshlrev_b32 v8, 12, v8
    v_lshl_add_u32 v8, v3, 3, v8
    s_lshl_b32 s16, s12, 6
    s_add_u32 s16, s16, 67108864
    s_lshl_b32 s17, s12, 16
    s_add_u32 s17, s17, 88080384
    v_mov_b32 v22, 0
    v_mov_b32 v23, 0
    v_add_u32 v14, s13, v4
    v_lshlrev_b32 v14, 13, v14
    v_lshl_add_u32 v14, v3, 3, v14
    s_add_u32 s19, s14, 100663296
    s_add_u32 s18, s16, 0
    buffer_load_dwordx2 v[16:17], v8, s[48:51], s18 offen
    buffer_load_dwordx2 v[18:19], v8, s[48:51], s18 offen offset:32
    buffer_load_dwordx2 v[20:21], v13, s[48:51], s17 offen offset:0
    s_waitcnt vmcnt(0)
    v_cmp_gt_u32 vcc, 2, v3
    s_nop 1
    v_cndmask_b32 v20, 0, v20, vcc
    v_cndmask_b32 v21, 0, v21, vcc
    s_nop 1
    v_mfma_f32_16x16x32_bf16 v[24:27], v[16:19], v[96:99], 0
    v_mfma_f32_16x16x32_bf16 v[24:27], v[20:23], v[100:103], v[24:27]
    s_nop 7
    s_nop 1
    v_cvt_pk_bf16_f32 v28, v24, v25
    v_cvt_pk_bf16_f32 v29, v26, v27
    s_add_u32 s20, s19, 0
    buffer_store_dwordx2 v[28:29], v14, s[48:51], s20 offen offset:0
    s_nop 1
    v_mfma_f32_16x16x32_bf16 v[24:27], v[16:19], v[104:107], 0
    v_mfma_f32_16x16x32_bf16 v[24:27], v[20:23], v[108:111], v[24:27]
    s_nop 7
    s_nop 1
    v_cvt_pk_bf16_f32 v28, v24, v25
    v_cvt_pk_bf16_f32 v29, v26, v27
    s_add_u32 s20, s19, 131072
    buffer_store_dwordx2 v[28:29], v14, s[48:51], s20 offen offset:0
    s_nop 1
    s_add_u32 s18, s16, 65536
    buffer_load_dwordx2 v[16:17], v8, s[48:51], s18 offen
    buffer_load_dwordx2 v[18:19], v8, s[48:51], s18 offen offset:32
    buffer_load_dwordx2 v[20:21], v13, s[48:51], s17 offen offset:256
    s_waitcnt vmcnt(0)
    v_cmp_gt_u32 vcc, 2, v3
    s_nop 1
    v_cndmask_b32 v20, 0, v20, vcc
    v_cndmask_b32 v21, 0, v21, vcc
    s_nop 1
    v_mfma_f32_16x16x32_bf16 v[24:27], v[16:19], v[96:99], 0
    v_mfma_f32_16x16x32_bf16 v[24:27], v[20:23], v[100:103], v[24:27]
    s_nop 7
    s_nop 1
    v_cvt_pk_bf16_f32 v28, v24, v25
    v_cvt_pk_bf16_f32 v29, v26, v27
    s_add_u32 s20, s19, 0
    buffer_store_dwordx2 v[28:29], v14, s[48:51], s20 offen offset:32
    s_nop 1
    v_mfma_f32_16x16x32_bf16 v[24:27], v[16:19], v[104:107], 0
    v_mfma_f32_16x16x32_bf16 v[24:27], v[20:23], v[108:111], v[24:27]
    s_nop 7
    s_nop 1
    v_cvt_pk_bf16_f32 v28, v24, v25
    v_cvt_pk_bf16_f32 v29, v26, v27
    s_add_u32 s20, s19, 131072
    buffer_store_dwordx2 v[28:29], v14, s[48:51], s20 offen offset:32
    s_nop 1
    s_add_u32 s18, s16, 131072
    buffer_load_dwordx2 v[16:17], v8, s[48:51], s18 offen
    buffer_load_dwordx2 v[18:19], v8, s[48:51], s18 offen offset:32
    buffer_load_dwordx2 v[20:21], v13, s[48:51], s17 offen offset:512
    s_waitcnt vmcnt(0)
    v_cmp_gt_u32 vcc, 2, v3
    s_nop 1
    v_cndmask_b32 v20, 0, v20, vcc
    v_cndmask_b32 v21, 0, v21, vcc
    s_nop 1
    v_mfma_f32_16x16x32_bf16 v[24:27], v[16:19], v[96:99], 0
    v_mfma_f32_16x16x32_bf16 v[24:27], v[20:23], v[100:103], v[24:27]
    s_nop 7
    s_nop 1
    v_cvt_pk_bf16_f32 v28, v24, v25
    v_cvt_pk_bf16_f32 v29, v26, v27
    s_add_u32 s20, s19, 0
    buffer_store_dwordx2 v[28:29], v14, s[48:51], s20 offen offset:64
    s_nop 1
    v_mfma_f32_16x16x32_bf16 v[24:27], v[16:19], v[104:107], 0
    v_mfma_f32_16x16x32_bf16 v[24:27], v[20:23], v[108:111], v[24:27]
    s_nop 7
    s_nop 1
    v_cvt_pk_bf16_f32 v28, v24, v25
    v_cvt_pk_bf16_f32 v29, v26, v27
    s_add_u32 s20, s19, 131072
    buffer_store_dwordx2 v[28:29], v14, s[48:51], s20 offen offset:64
    s_nop 1
    s_add_u32 s18, s16, 196608
    buffer_load_dwordx2 v[16:17], v8, s[48:51], s18 offen
    buffer_load_dwordx2 v[18:19], v8, s[48:51], s18 offen offset:32
    buffer_load_dwordx2 v[20:21], v13, s[48:51], s17 offen offset:768
    s_waitcnt vmcnt(0)
    v_cmp_gt_u32 vcc, 2, v3
    s_nop 1
    v_cndmask_b32 v20, 0, v20, vcc
    v_cndmask_b32 v21, 0, v21, vcc
    s_nop 1
    v_mfma_f32_16x16x32_bf16 v[24:27], v[16:19], v[96:99], 0
    v_mfma_f32_16x16x32_bf16 v[24:27], v[20:23], v[100:103], v[24:27]
    s_nop 7
    s_nop 1
    v_cvt_pk_bf16_f32 v28, v24, v25
    v_cvt_pk_bf16_f32 v29, v26, v27
    s_add_u32 s20, s19, 0
    buffer_store_dwordx2 v[28:29], v14, s[48:51], s20 offen offset:96
    s_nop 1
    v_mfma_f32_16x16x32_bf16 v[24:27], v[16:19], v[104:107], 0
    v_mfma_f32_16x16x32_bf16 v[24:27], v[20:23], v[108:111], v[24:27]
    s_nop 7
    s_nop 1
    v_cvt_pk_bf16_f32 v28, v24, v25
    v_cvt_pk_bf16_f32 v29, v26, v27
    s_add_u32 s20, s19, 131072
    buffer_store_dwordx2 v[28:29], v14, s[48:51], s20 offen offset:96
    s_nop 1
    s_add_u32 s18, s16, 262144
    buffer_load_dwordx2 v[16:17], v8, s[48:51], s18 offen
    buffer_load_dwordx2 v[18:19], v8, s[48:51], s18 offen offset:32
    buffer_load_dwordx2 v[20:21], v13, s[48:51], s17 offen offset:1024
    s_waitcnt vmcnt(0)
    v_cmp_gt_u32 vcc, 2, v3
    s_nop 1
    v_cndmask_b32 v20, 0, v20, vcc
    v_cndmask_b32 v21, 0, v21, vcc
    s_nop 1
    v_mfma_f32_16x16x32_bf16 v[24:27], v[16:19], v[96:99], 0
    v_mfma_f32_16x16x32_bf16 v[24:27], v[20:23], v[100:103], v[24:27]
    s_nop 7
    s_nop 1
    v_cvt_pk_bf16_f32 v28, v24, v25
    v_cvt_pk_bf16_f32 v29, v26, v27
    s_add_u32 s20, s19, 0
    buffer_store_dwordx2 v[28:29], v14, s[48:51], s20 offen offset:128
    s_nop 1
    v_mfma_f32_16x16x32_bf16 v[24:27], v[16:19], v[104:107], 0
    v_mfma_f32_16x16x32_bf16 v[24:27], v[20:23], v[108:111], v[24:27]
    s_nop 7
    s_nop 1
    v_cvt_pk_bf16_f32 v28, v24, v25
    v_cvt_pk_bf16_f32 v29, v26, v27
    s_add_u32 s20, s19, 131072
    buffer_store_dwordx2 v[28:29], v14, s[48:51], s20 offen offset:128
    s_nop 1
    s_add_u32 s18, s16, 327680
    buffer_load_dwordx2 v[16:17], v8, s[48:51], s18 offen
    buffer_load_dwordx2 v[18:19], v8, s[48:51], s18 offen offset:32
    buffer_load_dwordx2 v[20:21], v13, s[48:51], s17 offen offset:1280
    s_waitcnt vmcnt(0)
    v_cmp_gt_u32 vcc, 2, v3
    s_nop 1
    v_cndmask_b32 v20, 0, v20, vcc
    v_cndmask_b32 v21, 0, v21, vcc
    s_nop 1
    v_mfma_f32_16x16x32_bf16 v[24:27], v[16:19], v[96:99], 0
    v_mfma_f32_16x16x32_bf16 v[24:27], v[20:23], v[100:103], v[24:27]
    s_nop 7
    s_nop 1
    v_cvt_pk_bf16_f32 v28, v24, v25
    v_cvt_pk_bf16_f32 v29, v26, v27
    s_add_u32 s20, s19, 0
    buffer_store_dwordx2 v[28:29], v14, s[48:51], s20 offen offset:160
    s_nop 1
    v_mfma_f32_16x16x32_bf16 v[24:27], v[16:19], v[104:107], 0
    v_mfma_f32_16x16x32_bf16 v[24:27], v[20:23], v[108:111], v[24:27]
    s_nop 7
    s_nop 1
    v_cvt_pk_bf16_f32 v28, v24, v25
    v_cvt_pk_bf16_f32 v29, v26, v27
    s_add_u32 s20, s19, 131072
    buffer_store_dwordx2 v[28:29], v14, s[48:51], s20 offen offset:160
    s_nop 1
    s_add_u32 s18, s16, 393216
    buffer_load_dwordx2 v[16:17], v8, s[48:51], s18 offen
    buffer_load_dwordx2 v[18:19], v8, s[48:51], s18 offen offset:32
    buffer_load_dwordx2 v[20:21], v13, s[48:51], s17 offen offset:1536
    s_waitcnt vmcnt(0)
    v_cmp_gt_u32 vcc, 2, v3
    s_nop 1
    v_cndmask_b32 v20, 0, v20, vcc
    v_cndmask_b32 v21, 0, v21, vcc
    s_nop 1
    v_mfma_f32_16x16x32_bf16 v[24:27], v[16:19], v[96:99], 0
    v_mfma_f32_16x16x32_bf16 v[24:27], v[20:23], v[100:103], v[24:27]
    s_nop 7
    s_nop 1
    v_cvt_pk_bf16_f32 v28, v24, v25
    v_cvt_pk_bf16_f32 v29, v26, v27
    s_add_u32 s20, s19, 0
    buffer_store_dwordx2 v[28:29], v14, s[48:51], s20 offen offset:192
    s_nop 1
    v_mfma_f32_16x16x32_bf16 v[24:27], v[16:19], v[104:107], 0
    v_mfma_f32_16x16x32_bf16 v[24:27], v[20:23], v[108:111], v[24:27]
    s_nop 7
    s_nop 1
    v_cvt_pk_bf16_f32 v28, v24, v25
    v_cvt_pk_bf16_f32 v29, v26, v27
    s_add_u32 s20, s19, 131072
    buffer_store_dwordx2 v[28:29], v14, s[48:51], s20 offen offset:192
    s_nop 1
    s_add_u32 s18, s16, 458752
    buffer_load_dwordx2 v[16:17], v8, s[48:51], s18 offen
    buffer_load_dwordx2 v[18:19], v8, s[48:51], s18 offen offset:32
    buffer_load_dwordx2 v[20:21], v13, s[48:51], s17 offen offset:1792
    s_waitcnt vmcnt(0)
    v_cmp_gt_u32 vcc, 2, v3
    s_nop 1
    v_cndmask_b32 v20, 0, v20, vcc
    v_cndmask_b32 v21, 0, v21, vcc
    s_nop 1
    v_mfma_f32_16x16x32_bf16 v[24:27], v[16:19], v[96:99], 0
    v_mfma_f32_16x16x32_bf16 v[24:27], v[20:23], v[100:103], v[24:27]
    s_nop 7
    s_nop 1
    v_cvt_pk_bf16_f32 v28, v24, v25
    v_cvt_pk_bf16_f32 v29, v26, v27
    s_add_u32 s20, s19, 0
    buffer_store_dwordx2 v[28:29], v14, s[48:51], s20 offen offset:224
    s_nop 1
    v_mfma_f32_16x16x32_bf16 v[24:27], v[16:19], v[104:107], 0
    v_mfma_f32_16x16x32_bf16 v[24:27], v[20:23], v[108:111], v[24:27]
    s_nop 7
    s_nop 1
    v_cvt_pk_bf16_f32 v28, v24, v25
    v_cvt_pk_bf16_f32 v29, v26, v27
    s_add_u32 s20, s19, 131072
    buffer_store_dwordx2 v[28:29], v14, s[48:51], s20 offen offset:224
    s_nop 1
k4_end:
    s_endpgm
    .globl k5_kernel
    .p2align 8
    .type k5_kernel,@function
k5_kernel:
    s_cmp_ge_u32 s2, 256
    s_cbranch_scc1 k5_end
    s_load_dwordx2 s[32:33], s[0:1], 112
    s_load_dwordx2 s[34:35], s[0:1], 0
    s_load_dwordx2 s[36:37], s[0:1], 96
    v_lshrrev_b32 v1, 6, v0
    v_and_b32 v2, 63, v0
    v_readfirstlane_b32 s3, v1
    s_waitcnt lgkmcnt(0)
    s_mov_b32 s48, s32
    s_and_b32 s49, s33, 0xffff
    s_mov_b32 s50, 268435456
    s_mov_b32 s51, 0x00020000
    s_mov_b32 s52, s34
    s_and_b32 s53, s35, 0xffff
    s_mov_b32 s54, 2097152
    s_mov_b32 s55, 0x00020000
    s_mov_b32 s56, s36
    s_and_b32 s57, s37, 0xffff
    s_mov_b32 s58, 2097152
    s_mov_b32 s59, 0x00020000
    v_lshrrev_b32 v3, 4, v2
    v_and_b32 v4, 15, v2
    s_lshr_b32 s4, s2, 3
    s_lshl_b32 s4, s4, 6
    s_lshr_b32 s5, s3, 1
    s_lshl_b32 s5, s5, 5
    s_add_u32 s4, s4, s5
    s_and_b32 s5, s2, 7
    s_lshl_b32 s5, s5, 2
    s_and_b32 s6, s3, 1
    s_lshl_b32 s6, s6, 1
    s_add_u32 s5, s5, s6
    v_add_u32 v5, s4, v4
    v_lshlrev_b32 v5, 13, v5
    v_lshl_add_u32 v5, v3, 4, v5
    v_add_u32 v5, 100663296, v5
    v_lshlrev_b32 v6, 4, v2
    s_lshl_b32 s7, s5, 17
    s_add_u32 s7, s7, 20971520
    s_mov_b32 s8, 0
    v_mov_b32 v64, 0
    v_mov_b32 v65, 0
    v_mov_b32 v66, 0
    v_mov_b32 v67, 0
    v_mov_b32 v68, 0
    v_mov_b32 v69, 0
    v_mov_b32 v70, 0
    v_mov_b32 v71, 0
    v_mov_b32 v72, 0
    v_mov_b32 v73, 0
    v_mov_b32 v74, 0
    v_mov_b32 v75, 0
    v_mov_b32 v76, 0
    v_mov_b32 v77, 0
    v_mov_b32 v78, 0
    v_mov_b32 v79, 0
o_36:
    buffer_load_dwordx4 v[16:19], v5, s[48:51], 0 offen offset:0
    s_add_u32 s9, s7, 131072
    v_add_u32 v7, 131072, v5
    buffer_load_dwordx4 v[20:23], v7, s[48:51], 0 offen offset:0
    buffer_load_dwordx4 v[80:83], v6, s[48:51], s7 offen offset:0
    buffer_load_dwordx4 v[84:87], v6, s[48:51], s9 offen offset:0
    buffer_load_dwordx4 v[24:27], v5, s[48:51], 0 offen offset:64
    s_add_u32 s9, s7, 131072
    v_add_u32 v7, 131072, v5
    buffer_load_dwordx4 v[28:31], v7, s[48:51], 0 offen offset:64
    buffer_load_dwordx4 v[88:91], v6, s[48:51], s7 offen offset:1024
    buffer_load_dwordx4 v[92:95], v6, s[48:51], s9 offen offset:1024
    buffer_load_dwordx4 v[32:35], v5, s[48:51], 0 offen offset:128
    s_add_u32 s9, s7, 131072
    v_add_u32 v7, 131072, v5
    buffer_load_dwordx4 v[36:39], v7, s[48:51], 0 offen offset:128
    buffer_load_dwordx4 v[96:99], v6, s[48:51], s7 offen offset:2048
    buffer_load_dwordx4 v[100:103], v6, s[48:51], s9 offen offset:2048
    buffer_load_dwordx4 v[40:43], v5, s[48:51], 0 offen offset:192
    s_add_u32 s9, s7, 131072
    v_add_u32 v7, 131072, v5
    buffer_load_dwordx4 v[44:47], v7, s[48:51], 0 offen offset:192
    buffer_load_dwordx4 v[104:107], v6, s[48:51], s7 offen offset:3072
    buffer_load_dwordx4 v[108:111], v6, s[48:51], s9 offen offset:3072
    s_waitcnt vmcnt(0)
    v_mfma_f32_16x16x32_bf16 v[64:67], v[16:19], v[80:83], v[64:67]
    v_mfma_f32_16x16x32_bf16 v[68:71], v[16:19], v[84:87], v[68:71]
    v_mfma_f32_16x16x32_bf16 v[72:75], v[20:23], v[80:83], v[72:75]
    v_mfma_f32_16x16x32_bf16 v[76:79], v[20:23], v[84:87], v[76:79]
    v_mfma_f32_16x16x32_bf16 v[64:67], v[24:27], v[88:91], v[64:67]
    v_mfma_f32_16x16x32_bf16 v[68:71], v[24:27], v[92:95], v[68:71]
    v_mfma_f32_16x16x32_bf16 v[72:75], v[28:31], v[88:91], v[72:75]
    v_mfma_f32_16x16x32_bf16 v[76:79], v[28:31], v[92:95], v[76:79]
    v_mfma_f32_16x16x32_bf16 v[64:67], v[32:35], v[96:99], v[64:67]
    v_mfma_f32_16x16x32_bf16 v[68:71], v[32:35], v[100:103], v[68:71]
    v_mfma_f32_16x16x32_bf16 v[72:75], v[36:39], v[96:99], v[72:75]
    v_mfma_f32_16x16x32_bf16 v[76:79], v[36:39], v[100:103], v[76:79]
    v_mfma_f32_16x16x32_bf16 v[64:67], v[40:43], v[104:107], v[64:67]
    v_mfma_f32_16x16x32_bf16 v[68:71], v[40:43], v[108:111], v[68:71]
    v_mfma_f32_16x16x32_bf16 v[72:75], v[44:47], v[104:107], v[72:75]
    v_mfma_f32_16x16x32_bf16 v[76:79], v[44:47], v[108:111], v[76:79]
    v_add_u32 v5, 256, v5
    s_add_u32 s7, s7, 4096
    s_add_u32 s8, s8, 1
    s_cmp_lt_u32 s8, 32
    s_cbranch_scc1 o_36
    s_nop 7
    s_nop 7
    v_lshl_add_u32 v8, v3, 2, 0
    v_add_u32 v8, s4, v8
    v_lshlrev_b32 v8, 9, v8
    s_add_u32 s9, s5, 0
    s_lshl_b32 s9, s9, 4
    v_add_u32 v8, s9, v8
    v_add_u32 v8, v4, v8
    v_lshlrev_b32 v8, 1, v8
    v_add_u32 v9, 2097152, v8
    buffer_load_ushort v10, v9, s[48:51], 0 offen
    buffer_load_ushort v11, v8, s[52:55], 0 offen
    s_waitcnt vmcnt(0)
    v_lshlrev_b32 v10, 16, v10
    v_lshlrev_b32 v11, 16, v11
    v_cvt_pk_bf16_f32 v64, v64, v64
    v_lshlrev_b32 v64, 16, v64
    v_mul_f32 v64, v64, v10
    v_cvt_pk_bf16_f32 v64, v64, v64
    v_lshlrev_b32 v64, 16, v64
    v_add_f32 v64, v64, v11
    v_cvt_pk_bf16_f32 v64, v64, v64
    buffer_store_short v64, v8, s[56:59], 0 offen
    v_lshl_add_u32 v8, v3, 2, 1
    v_add_u32 v8, s4, v8
    v_lshlrev_b32 v8, 9, v8
    s_add_u32 s9, s5, 0
    s_lshl_b32 s9, s9, 4
    v_add_u32 v8, s9, v8
    v_add_u32 v8, v4, v8
    v_lshlrev_b32 v8, 1, v8
    v_add_u32 v9, 2097152, v8
    buffer_load_ushort v10, v9, s[48:51], 0 offen
    buffer_load_ushort v11, v8, s[52:55], 0 offen
    s_waitcnt vmcnt(0)
    v_lshlrev_b32 v10, 16, v10
    v_lshlrev_b32 v11, 16, v11
    v_cvt_pk_bf16_f32 v65, v65, v65
    v_lshlrev_b32 v65, 16, v65
    v_mul_f32 v65, v65, v10
    v_cvt_pk_bf16_f32 v65, v65, v65
    v_lshlrev_b32 v65, 16, v65
    v_add_f32 v65, v65, v11
    v_cvt_pk_bf16_f32 v65, v65, v65
    buffer_store_short v65, v8, s[56:59], 0 offen
    v_lshl_add_u32 v8, v3, 2, 2
    v_add_u32 v8, s4, v8
    v_lshlrev_b32 v8, 9, v8
    s_add_u32 s9, s5, 0
    s_lshl_b32 s9, s9, 4
    v_add_u32 v8, s9, v8
    v_add_u32 v8, v4, v8
    v_lshlrev_b32 v8, 1, v8
    v_add_u32 v9, 2097152, v8
    buffer_load_ushort v10, v9, s[48:51], 0 offen
    buffer_load_ushort v11, v8, s[52:55], 0 offen
    s_waitcnt vmcnt(0)
    v_lshlrev_b32 v10, 16, v10
    v_lshlrev_b32 v11, 16, v11
    v_cvt_pk_bf16_f32 v66, v66, v66
    v_lshlrev_b32 v66, 16, v66
    v_mul_f32 v66, v66, v10
    v_cvt_pk_bf16_f32 v66, v66, v66
    v_lshlrev_b32 v66, 16, v66
    v_add_f32 v66, v66, v11
    v_cvt_pk_bf16_f32 v66, v66, v66
    buffer_store_short v66, v8, s[56:59], 0 offen
    v_lshl_add_u32 v8, v3, 2, 3
    v_add_u32 v8, s4, v8
    v_lshlrev_b32 v8, 9, v8
    s_add_u32 s9, s5, 0
    s_lshl_b32 s9, s9, 4
    v_add_u32 v8, s9, v8
    v_add_u32 v8, v4, v8
    v_lshlrev_b32 v8, 1, v8
    v_add_u32 v9, 2097152, v8
    buffer_load_ushort v10, v9, s[48:51], 0 offen
    buffer_load_ushort v11, v8, s[52:55], 0 offen
    s_waitcnt vmcnt(0)
    v_lshlrev_b32 v10, 16, v10
    v_lshlrev_b32 v11, 16, v11
    v_cvt_pk_bf16_f32 v67, v67, v67
    v_lshlrev_b32 v67, 16, v67
    v_mul_f32 v67, v67, v10
    v_cvt_pk_bf16_f32 v67, v67, v67
    v_lshlrev_b32 v67, 16, v67
    v_add_f32 v67, v67, v11
    v_cvt_pk_bf16_f32 v67, v67, v67
    buffer_store_short v67, v8, s[56:59], 0 offen
    v_lshl_add_u32 v8, v3, 2, 0
    v_add_u32 v8, s4, v8
    v_lshlrev_b32 v8, 9, v8
    s_add_u32 s9, s5, 1
    s_lshl_b32 s9, s9, 4
    v_add_u32 v8, s9, v8
    v_add_u32 v8, v4, v8
    v_lshlrev_b32 v8, 1, v8
    v_add_u32 v9, 2097152, v8
    buffer_load_ushort v10, v9, s[48:51], 0 offen
    buffer_load_ushort v11, v8, s[52:55], 0 offen
    s_waitcnt vmcnt(0)
    v_lshlrev_b32 v10, 16, v10
    v_lshlrev_b32 v11, 16, v11
    v_cvt_pk_bf16_f32 v68, v68, v68
    v_lshlrev_b32 v68, 16, v68
    v_mul_f32 v68, v68, v10
    v_cvt_pk_bf16_f32 v68, v68, v68
    v_lshlrev_b32 v68, 16, v68
    v_add_f32 v68, v68, v11
    v_cvt_pk_bf16_f32 v68, v68, v68
    buffer_store_short v68, v8, s[56:59], 0 offen
    v_lshl_add_u32 v8, v3, 2, 1
    v_add_u32 v8, s4, v8
    v_lshlrev_b32 v8, 9, v8
    s_add_u32 s9, s5, 1
    s_lshl_b32 s9, s9, 4
    v_add_u32 v8, s9, v8
    v_add_u32 v8, v4, v8
    v_lshlrev_b32 v8, 1, v8
    v_add_u32 v9, 2097152, v8
    buffer_load_ushort v10, v9, s[48:51], 0 offen
    buffer_load_ushort v11, v8, s[52:55], 0 offen
    s_waitcnt vmcnt(0)
    v_lshlrev_b32 v10, 16, v10
    v_lshlrev_b32 v11, 16, v11
    v_cvt_pk_bf16_f32 v69, v69, v69
    v_lshlrev_b32 v69, 16, v69
    v_mul_f32 v69, v69, v10
    v_cvt_pk_bf16_f32 v69, v69, v69
    v_lshlrev_b32 v69, 16, v69
    v_add_f32 v69, v69, v11
    v_cvt_pk_bf16_f32 v69, v69, v69
    buffer_store_short v69, v8, s[56:59], 0 offen
    v_lshl_add_u32 v8, v3, 2, 2
    v_add_u32 v8, s4, v8
    v_lshlrev_b32 v8, 9, v8
    s_add_u32 s9, s5, 1
    s_lshl_b32 s9, s9, 4
    v_add_u32 v8, s9, v8
    v_add_u32 v8, v4, v8
    v_lshlrev_b32 v8, 1, v8
    v_add_u32 v9, 2097152, v8
    buffer_load_ushort v10, v9, s[48:51], 0 offen
    buffer_load_ushort v11, v8, s[52:55], 0 offen
    s_waitcnt vmcnt(0)
    v_lshlrev_b32 v10, 16, v10
    v_lshlrev_b32 v11, 16, v11
    v_cvt_pk_bf16_f32 v70, v70, v70
    v_lshlrev_b32 v70, 16, v70
    v_mul_f32 v70, v70, v10
    v_cvt_pk_bf16_f32 v70, v70, v70
    v_lshlrev_b32 v70, 16, v70
    v_add_f32 v70, v70, v11
    v_cvt_pk_bf16_f32 v70, v70, v70
    buffer_store_short v70, v8, s[56:59], 0 offen
    v_lshl_add_u32 v8, v3, 2, 3
    v_add_u32 v8, s4, v8
    v_lshlrev_b32 v8, 9, v8
    s_add_u32 s9, s5, 1
    s_lshl_b32 s9, s9, 4
    v_add_u32 v8, s9, v8
    v_add_u32 v8, v4, v8
    v_lshlrev_b32 v8, 1, v8
    v_add_u32 v9, 2097152, v8
    buffer_load_ushort v10, v9, s[48:51], 0 offen
    buffer_load_ushort v11, v8, s[52:55], 0 offen
    s_waitcnt vmcnt(0)
    v_lshlrev_b32 v10, 16, v10
    v_lshlrev_b32 v11, 16, v11
    v_cvt_pk_bf16_f32 v71, v71, v71
    v_lshlrev_b32 v71, 16, v71
    v_mul_f32 v71, v71, v10
    v_cvt_pk_bf16_f32 v71, v71, v71
    v_lshlrev_b32 v71, 16, v71
    v_add_f32 v71, v71, v11
    v_cvt_pk_bf16_f32 v71, v71, v71
    buffer_store_short v71, v8, s[56:59], 0 offen
    v_lshl_add_u32 v8, v3, 2, 16
    v_add_u32 v8, s4, v8
    v_lshlrev_b32 v8, 9, v8
    s_add_u32 s9, s5, 0
    s_lshl_b32 s9, s9, 4
    v_add_u32 v8, s9, v8
    v_add_u32 v8, v4, v8
    v_lshlrev_b32 v8, 1, v8
    v_add_u32 v9, 2097152, v8
    buffer_load_ushort v10, v9, s[48:51], 0 offen
    buffer_load_ushort v11, v8, s[52:55], 0 offen
    s_waitcnt vmcnt(0)
    v_lshlrev_b32 v10, 16, v10
    v_lshlrev_b32 v11, 16, v11
    v_cvt_pk_bf16_f32 v72, v72, v72
    v_lshlrev_b32 v72, 16, v72
    v_mul_f32 v72, v72, v10
    v_cvt_pk_bf16_f32 v72, v72, v72
    v_lshlrev_b32 v72, 16, v72
    v_add_f32 v72, v72, v11
    v_cvt_pk_bf16_f32 v72, v72, v72
    buffer_store_short v72, v8, s[56:59], 0 offen
    v_lshl_add_u32 v8, v3, 2, 17
    v_add_u32 v8, s4, v8
    v_lshlrev_b32 v8, 9, v8
    s_add_u32 s9, s5, 0
    s_lshl_b32 s9, s9, 4
    v_add_u32 v8, s9, v8
    v_add_u32 v8, v4, v8
    v_lshlrev_b32 v8, 1, v8
    v_add_u32 v9, 2097152, v8
    buffer_load_ushort v10, v9, s[48:51], 0 offen
    buffer_load_ushort v11, v8, s[52:55], 0 offen
    s_waitcnt vmcnt(0)
    v_lshlrev_b32 v10, 16, v10
    v_lshlrev_b32 v11, 16, v11
    v_cvt_pk_bf16_f32 v73, v73, v73
    v_lshlrev_b32 v73, 16, v73
    v_mul_f32 v73, v73, v10
    v_cvt_pk_bf16_f32 v73, v73, v73
    v_lshlrev_b32 v73, 16, v73
    v_add_f32 v73, v73, v11
    v_cvt_pk_bf16_f32 v73, v73, v73
    buffer_store_short v73, v8, s[56:59], 0 offen
    v_lshl_add_u32 v8, v3, 2, 18
    v_add_u32 v8, s4, v8
    v_lshlrev_b32 v8, 9, v8
    s_add_u32 s9, s5, 0
    s_lshl_b32 s9, s9, 4
    v_add_u32 v8, s9, v8
    v_add_u32 v8, v4, v8
    v_lshlrev_b32 v8, 1, v8
    v_add_u32 v9, 2097152, v8
    buffer_load_ushort v10, v9, s[48:51], 0 offen
    buffer_load_ushort v11, v8, s[52:55], 0 offen
    s_waitcnt vmcnt(0)
    v_lshlrev_b32 v10, 16, v10
    v_lshlrev_b32 v11, 16, v11
    v_cvt_pk_bf16_f32 v74, v74, v74
    v_lshlrev_b32 v74, 16, v74
    v_mul_f32 v74, v74, v10
    v_cvt_pk_bf16_f32 v74, v74, v74
    v_lshlrev_b32 v74, 16, v74
    v_add_f32 v74, v74, v11
    v_cvt_pk_bf16_f32 v74, v74, v74
    buffer_store_short v74, v8, s[56:59], 0 offen
    v_lshl_add_u32 v8, v3, 2, 19
    v_add_u32 v8, s4, v8
    v_lshlrev_b32 v8, 9, v8
    s_add_u32 s9, s5, 0
    s_lshl_b32 s9, s9, 4
    v_add_u32 v8, s9, v8
    v_add_u32 v8, v4, v8
    v_lshlrev_b32 v8, 1, v8
    v_add_u32 v9, 2097152, v8
    buffer_load_ushort v10, v9, s[48:51], 0 offen
    buffer_load_ushort v11, v8, s[52:55], 0 offen
    s_waitcnt vmcnt(0)
    v_lshlrev_b32 v10, 16, v10
    v_lshlrev_b32 v11, 16, v11
    v_cvt_pk_bf16_f32 v75, v75, v75
    v_lshlrev_b32 v75, 16, v75
    v_mul_f32 v75, v75, v10
    v_cvt_pk_bf16_f32 v75, v75, v75
    v_lshlrev_b32 v75, 16, v75
    v_add_f32 v75, v75, v11
    v_cvt_pk_bf16_f32 v75, v75, v75
    buffer_store_short v75, v8, s[56:59], 0 offen
    v_lshl_add_u32 v8, v3, 2, 16
    v_add_u32 v8, s4, v8
    v_lshlrev_b32 v8, 9, v8
    s_add_u32 s9, s5, 1
    s_lshl_b32 s9, s9, 4
    v_add_u32 v8, s9, v8
    v_add_u32 v8, v4, v8
    v_lshlrev_b32 v8, 1, v8
    v_add_u32 v9, 2097152, v8
    buffer_load_ushort v10, v9, s[48:51], 0 offen
    buffer_load_ushort v11, v8, s[52:55], 0 offen
    s_waitcnt vmcnt(0)
    v_lshlrev_b32 v10, 16, v10
    v_lshlrev_b32 v11, 16, v11
    v_cvt_pk_bf16_f32 v76, v76, v76
    v_lshlrev_b32 v76, 16, v76
    v_mul_f32 v76, v76, v10
    v_cvt_pk_bf16_f32 v76, v76, v76
    v_lshlrev_b32 v76, 16, v76
    v_add_f32 v76, v76, v11
    v_cvt_pk_bf16_f32 v76, v76, v76
    buffer_store_short v76, v8, s[56:59], 0 offen
    v_lshl_add_u32 v8, v3, 2, 17
    v_add_u32 v8, s4, v8
    v_lshlrev_b32 v8, 9, v8
    s_add_u32 s9, s5, 1
    s_lshl_b32 s9, s9, 4
    v_add_u32 v8, s9, v8
    v_add_u32 v8, v4, v8
    v_lshlrev_b32 v8, 1, v8
    v_add_u32 v9, 2097152, v8
    buffer_load_ushort v10, v9, s[48:51], 0 offen
    buffer_load_ushort v11, v8, s[52:55], 0 offen
    s_waitcnt vmcnt(0)
    v_lshlrev_b32 v10, 16, v10
    v_lshlrev_b32 v11, 16, v11
    v_cvt_pk_bf16_f32 v77, v77, v77
    v_lshlrev_b32 v77, 16, v77
    v_mul_f32 v77, v77, v10
    v_cvt_pk_bf16_f32 v77, v77, v77
    v_lshlrev_b32 v77, 16, v77
    v_add_f32 v77, v77, v11
    v_cvt_pk_bf16_f32 v77, v77, v77
    buffer_store_short v77, v8, s[56:59], 0 offen
    v_lshl_add_u32 v8, v3, 2, 18
    v_add_u32 v8, s4, v8
    v_lshlrev_b32 v8, 9, v8
    s_add_u32 s9, s5, 1
    s_lshl_b32 s9, s9, 4
    v_add_u32 v8, s9, v8
    v_add_u32 v8, v4, v8
    v_lshlrev_b32 v8, 1, v8
    v_add_u32 v9, 2097152, v8
    buffer_load_ushort v10, v9, s[48:51], 0 offen
    buffer_load_ushort v11, v8, s[52:55], 0 offen
    s_waitcnt vmcnt(0)
    v_lshlrev_b32 v10, 16, v10
    v_lshlrev_b32 v11, 16, v11
    v_cvt_pk_bf16_f32 v78, v78, v78
    v_lshlrev_b32 v78, 16, v78
    v_mul_f32 v78, v78, v10
    v_cvt_pk_bf16_f32 v78, v78, v78
    v_lshlrev_b32 v78, 16, v78
    v_add_f32 v78, v78, v11
    v_cvt_pk_bf16_f32 v78, v78, v78
    buffer_store_short v78, v8, s[56:59], 0 offen
    v_lshl_add_u32 v8, v3, 2, 19
    v_add_u32 v8, s4, v8
    v_lshlrev_b32 v8, 9, v8
    s_add_u32 s9, s5, 1
    s_lshl_b32 s9, s9, 4
    v_add_u32 v8, s9, v8
    v_add_u32 v8, v4, v8
    v_lshlrev_b32 v8, 1, v8
    v_add_u32 v9, 2097152, v8
    buffer_load_ushort v10, v9, s[48:51], 0 offen
    buffer_load_ushort v11, v8, s[52:55], 0 offen
    s_waitcnt vmcnt(0)
    v_lshlrev_b32 v10, 16, v10
    v_lshlrev_b32 v11, 16, v11
    v_cvt_pk_bf16_f32 v79, v79, v79
    v_lshlrev_b32 v79, 16, v79
    v_mul_f32 v79, v79, v10
    v_cvt_pk_bf16_f32 v79, v79, v79
    v_lshlrev_b32 v79, 16, v79
    v_add_f32 v79, v79, v11
    v_cvt_pk_bf16_f32 v79, v79, v79
    buffer_store_short v79, v8, s[56:59], 0 offen
k5_end:
    s_endpgm
.section .rodata,"a"
.p2align 6
.amdhsa_kernel k0_kernel
  .amdhsa_next_free_vgpr 32
  .amdhsa_next_free_sgpr 102
  .amdhsa_accum_offset 32
  .amdhsa_group_segment_fixed_size 0
  .amdhsa_kernarg_size 120
  .amdhsa_user_sgpr_count 2
  .amdhsa_user_sgpr_kernarg_segment_ptr 1
  .amdhsa_system_sgpr_workgroup_id_x 1
.end_amdhsa_kernel
.p2align 6
.amdhsa_kernel k2_kernel
  .amdhsa_next_free_vgpr 512
  .amdhsa_next_free_sgpr 102
  .amdhsa_accum_offset 256
  .amdhsa_group_segment_fixed_size 0
  .amdhsa_kernarg_size 120
  .amdhsa_user_sgpr_count 2
  .amdhsa_user_sgpr_kernarg_segment_ptr 1
  .amdhsa_system_sgpr_workgroup_id_x 1
.end_amdhsa_kernel
.p2align 6
.amdhsa_kernel k3_kernel
  .amdhsa_next_free_vgpr 512
  .amdhsa_next_free_sgpr 102
  .amdhsa_accum_offset 256
  .amdhsa_group_segment_fixed_size 0
  .amdhsa_kernarg_size 120
  .amdhsa_user_sgpr_count 2
  .amdhsa_user_sgpr_kernarg_segment_ptr 1
  .amdhsa_system_sgpr_workgroup_id_x 1
.end_amdhsa_kernel
.p2align 6
.amdhsa_kernel k4_kernel
  .amdhsa_next_free_vgpr 128
  .amdhsa_next_free_sgpr 102
  .amdhsa_accum_offset 128
  .amdhsa_group_segment_fixed_size 0
  .amdhsa_kernarg_size 120
  .amdhsa_user_sgpr_count 2
  .amdhsa_user_sgpr_kernarg_segment_ptr 1
  .amdhsa_system_sgpr_workgroup_id_x 1
.end_amdhsa_kernel
.p2align 6
.amdhsa_kernel k5_kernel
  .amdhsa_next_free_vgpr 128
  .amdhsa_next_free_sgpr 102
  .amdhsa_accum_offset 128
  .amdhsa_group_segment_fixed_size 0
  .amdhsa_kernarg_size 120
  .amdhsa_user_sgpr_count 2
  .amdhsa_user_sgpr_kernarg_segment_ptr 1
  .amdhsa_system_sgpr_workgroup_id_x 1
.end_amdhsa_kernel
```
